```python
import torch

def _softmax(x, axis=-1):
    return torch.softmax(x, dim=axis)
def _gelu(x):
    return torch.nn.functional.gelu(x, approximate="tanh")
def _silu(x):
    return torch.nn.functional.silu(x)
def _sigmoid(x):
    return torch.sigmoid(x)
def _layernorm(x, axis=-1, eps=1e-5):
    m = x.mean(dim=axis, keepdim=True)
    v = x.var(dim=axis, keepdim=True, unbiased=False)
    return (x - m) / torch.sqrt(v + eps)
def _scatter_add(tgt, idx, src, axis=0):
    return tgt.clone().index_add_(axis, idx, src)
def _segment_sum(src, seg, n):
    out = torch.zeros((n,) + src.shape[1:], dtype=src.dtype)
    return out.index_add_(0, seg, src)
def _pad(x, pw):
    flat = tuple(v for pair in reversed(pw) for v in pair)
    return torch.nn.functional.pad(x, flat)

kernel_name = 'standalone__paged_block_table_kv_radixattention__decode'

def setup_inputs():

    _w = (lambda a: (lambda t: t.to(torch.bfloat16) if t.is_floating_point() else t)(torch.as_tensor(a)))
    B, H, Hkv, Dh = 8, 32, 8, 128
    Lk = 4096
    bs = 16
    nb = max(2, Lk // bs)
    P = max(1, nb // 2)
    n_phys = P + B * (nb - P)
    shared = torch.arange(P, dtype=torch.int64)
    priv = P + torch.arange(B * (nb - P), dtype=torch.int64).reshape(B, nb - P)
    bt = torch.cat([torch.tile(shared[None, :], (B, 1)), priv], dim=1)
    ctx = nb * bs - (torch.arange(1, B + 1, dtype=torch.int64) * 2654435761) % max(1, (nb * bs - P * bs) // 2)
    return {
        "q": _w((lambda *s: torch.randn(*s, dtype=torch.bfloat16) * 0.8)(B, H, Dh)),
        "k_cache": _w((lambda *s: torch.randn(*s, dtype=torch.bfloat16) * 0.8)(n_phys, bs, Hkv, Dh)),
        "v_cache": _w((lambda *s: torch.randn(*s, dtype=torch.bfloat16) * 0.05)(n_phys, bs, Hkv, Dh)),
        "block_table": _w(bt.to(torch.int64)),
        "ctx_lens": _w(torch.as_tensor(ctx).to(torch.int64)),
    }

def reference(q, k_cache, v_cache, block_table, ctx_lens):
    B, H, Dh = q.shape
    n_phys, bs, Hkv, _ = k_cache.shape
    nb = block_table.shape[1]
    Lk = nb * bs
    rep = H // Hkv
    k = k_cache[block_table].reshape(B, Lk, Hkv, Dh)
    v = v_cache[block_table].reshape(B, Lk, Hkv, Dh)
    k = (lambda x, n, axis: torch.repeat_interleave(x, n, dim=axis))(k, rep, axis=2)
    v = (lambda x, n, axis: torch.repeat_interleave(x, n, dim=axis))(v, rep, axis=2)
    scores = torch.einsum("bhd,bkhd->bhk", q, k) * (Dh ** -0.5)
    pos = torch.arange(Lk)
    valid = pos[None, :] < ctx_lens[:, None]
    scores = torch.where(valid[:, None, :], scores, -1e9)
    p = _softmax(scores, axis=-1)
    return torch.einsum("bhk,bkhd->bhd", p, v)
```

```asm
; @launch grid=(256,1,1) block=(256,1,1) lds=139328
.amdgcn_target "amdgcn-amd-amdhsa--gfx950"
.text
.globl standalone__paged_block_table_kv_radixattention__decode_kernel
.p2align 8
.type standalone__paged_block_table_kv_radixattention__decode_kernel,@function
standalone__paged_block_table_kv_radixattention__decode_kernel:
  s_cmp_ge_u32 s2, 256
  s_cbranch_scc1 L_end
  s_load_dwordx16 s[16:31], s[0:1], 0
  v_lshrrev_b32 v26, 6, v0
  s_lshr_b32 s5, s2, 3
  s_add_u32 s5, s5, 6
  s_and_b32 s5, s5, 31
  v_bfe_u32 v2, v0, 4, 2
  v_readfirstlane_b32 s3, v26
  v_and_b32 v3, 15, v0
  s_sub_u32 s15, s5, 6
  v_xor_b32 v26, v3, v2
  v_lshlrev_b32 v27, 11, v2
  s_and_b32 s4, s2, 7
  v_lshl_add_u32 v4, v26, 4, v27
  s_lshl_b32 m0, s3, 15
  v_xor_b32 v5, 64, v4
  v_xor_b32 v6, 128, v4
  v_xor_b32 v7, 192, v4
  s_movk_i32 s84, 0x400
  s_movk_i32 s85, 0x2000
  s_mov_b32 s34, 37748736
  s_mov_b32 s35, 0x20000
  s_cmp_lt_u32 s15, 16
  s_cbranch_scc0 L_other_role
  s_lshr_b32 s93, s15, 1
  s_and_b32 s8, s15, 1
  s_lshl2_add_u32 s91, s93, s8
  s_lshl2_add_u32 s91, s91, s3
  s_add_u32 s91, s91, 16
  s_lshl_b32 s91, s91, 3
L_k0:
  s_lshl_b32 s91, s91, 15
  s_lshl_b32 s9, s4, 8
  s_or_b32 s91, s91, s9
  s_waitcnt lgkmcnt(0)
  s_mov_b32 s32, s18
  s_mov_b32 s33, s19
  buffer_load_dwordx4 v4, s[32:35], s91 offen nt lds
  s_add_u32 m0, m0, s84
  s_add_u32 s91, s91, s85
  buffer_load_dwordx4 v5, s[32:35], s91 offen nt lds
  s_add_u32 m0, m0, s84
  s_add_u32 s91, s91, s85
  buffer_load_dwordx4 v6, s[32:35], s91 offen nt lds
  s_add_u32 m0, m0, s84
  s_add_u32 s91, s91, s85
  buffer_load_dwordx4 v7, s[32:35], s91 offen nt lds
  s_add_u32 m0, m0, s84
  s_add_u32 s91, s91, s85
  s_load_dwordx8 s[60:67], s[24:25], 0
  s_getpc_b64 s[96:97]
L_pc:
  s_lshr_b32 s15, s2, 3
  v_lshlrev_b32 v26, 7, v0
  s_mul_i32 s15, s15, 2048
  v_cmp_gt_u32 vcc, 16, v0
  v_add_u32 v26, s15, v26
  v_min_u32 v26, L_end-L_pc, v26
  s_and_saveexec_b64 s[94:95], vcc
  s_cbranch_execz L_cpf_done
  global_load_dword v60, v26, s[96:97]
L_cpf_done:
  s_mov_b64 exec, -1
  v_and_b32 v1, 63, v0
  s_lshl_b32 s77, s3, 15
  s_mov_b32 s51, 0
  s_cmp_lt_u32 s5, 6
  s_cbranch_scc1 L_sh_book
  s_mov_b32 s0, 0
  s_add_u32 s50, s8, 6
  s_lshl_b32 s8, s8, 5
  s_lshr_b32 s7, s93, 2
  s_add_u32 s9, s8, 32
  s_mov_b32 s6, 0
  s_sub_u32 s15, s9, s8
  s_mul_i32 s10, s15, s3
  s_add_u32 s11, s10, s15
  s_lshr_b32 s10, s10, 2
  s_lshr_b32 s11, s11, 2
  s_sub_u32 s11, s11, s10
  s_add_u32 s10, s10, s8
L_sh_book:
  s_mov_b32 s40, s16
  s_and_b32 s41, s17, 0xffff
  s_mov_b32 s42, 65536
  s_mov_b32 s43, 0x20000
  s_lshl_b32 s15, s3, 6
  v_lshlrev_b32 v26, 8, v2
  v_and_b32 v27, 0xf0, v4
  v_xor_b32 v27, s15, v27
  v_or_b32 v26, v26, v27
  s_lshl_b32 s15, s7, 2
  s_add_u32 s15, s15, s3
  s_lshl_b32 s15, s15, 13
  s_lshl_b32 s19, s4, 10
  s_add_u32 s15, s15, s19
  s_mov_b32 s19, m0
  s_lshl_b32 s1, s3, 10
  s_add_u32 m0, s1, 131072
  s_nop 0
  buffer_load_dwordx4 v26, s[40:43], s15 offen lds
  s_add_u32 m0, m0, 0x1000
  s_add_u32 s15, s15, 32768
  s_cmp_lg_u32 s6, 0
  s_cselect_b32 s42, 65536, 0
  buffer_load_dwordx4 v26, s[40:43], s15 offen lds
  s_mov_b32 m0, s19
  s_nop 0
  buffer_load_dwordx4 v4, s[32:35], s91 offen nt lds
  s_add_u32 m0, m0, s84
  s_add_u32 s91, s91, s85
  buffer_load_dwordx4 v5, s[32:35], s91 offen nt lds
  s_add_u32 m0, m0, s84
  s_add_u32 s91, s91, s85
  buffer_load_dwordx4 v6, s[32:35], s91 offen nt lds
  s_add_u32 m0, m0, s84
  s_add_u32 s91, s91, s85
  buffer_load_dwordx4 v7, s[32:35], s91 offen nt lds
  s_add_u32 m0, m0, s84
  s_add_u32 s91, s91, s85
  buffer_load_dwordx4 v4, s[32:35], s91 offen nt lds
  s_add_u32 m0, m0, s84
  s_add_u32 s91, s91, s85
  buffer_load_dwordx4 v5, s[32:35], s91 offen nt lds
  s_add_u32 m0, m0, s84
  s_add_u32 s91, s91, s85
  buffer_load_dwordx4 v6, s[32:35], s91 offen nt lds
  s_add_u32 m0, m0, s84
  s_add_u32 s91, s91, s85
  buffer_load_dwordx4 v7, s[32:35], s91 offen nt lds
  s_add_u32 m0, m0, s84
  s_add_u32 s91, s91, s85
  s_cmp_lt_u32 s5, 6
  s_cbranch_scc1 L_sh_desc
  v_add_u32 v27, s10, v1
  v_cmp_gt_u32_e64 s[94:95], s11, v1
  v_mov_b32 v26, s93
  v_add_u32 v27, 128, v27
  s_add_u32 s92, s93, 16
  v_lshlrev_b32_e64 v28, s92, 1
  s_add_u32 s12, s11, 7
  s_lshr_b32 s12, s12, 3
L_desc_addr:
  v_min_u32 v27, 255, v27
  s_mov_b32 s44, s22
  s_and_b32 s45, s23, 0xffff
  s_mov_b32 s46, 8192
  s_mov_b32 s47, 0x20000
  v_lshlrev_b32 v29, 2, v27
  v_lshl_add_u32 v29, v26, 10, v29
  v_lshl_add_u32 v63, v26, 7, v27
  v_cmp_gt_u32 vcc, 128, v27
  v_cndmask_b32_e64 v28, 0, v28, s[94:95]
  s_lshl_b32 s15, s4, 8
  v_cndmask_b32 v63, v63, v27, vcc
  v_lshlrev_b32 v27, 4, v27
  v_lshlrev_b32 v19, 15, v63
  v_or_b32 v20, v28, v27
  v_add_u32 v19, s15, v19
  v_mov_b32 v62, v29
  s_mov_b32 s13, 0
  v_readlane_b32 s78, v19, 0
  v_readlane_b32 s86, v20, 0
  v_readlane_b32 s79, v19, 1
  v_readlane_b32 s87, v20, 1
  v_readlane_b32 s80, v19, 2
  v_readlane_b32 s88, v20, 2
  v_readlane_b32 s81, v19, 3
  v_readlane_b32 s89, v20, 3
  v_readlane_b32 s82, v19, 4
  v_readlane_b32 s90, v20, 4
  v_readlane_b32 s83, v19, 5
  v_readlane_b32 s91, v20, 5
  v_readlane_b32 s84, v19, 6
  v_readlane_b32 s92, v20, 6
  v_readlane_b32 s85, v19, 7
  v_readlane_b32 s93, v20, 7
  s_cmp_lg_u32 s0, 0
  s_cbranch_scc0 L_loads_done
  s_mov_b32 s32, s18
  s_and_b32 s33, s19, 0xffff
  s_mov_b32 s34, 37748736
  s_mov_b32 s35, 0x20000
  s_cmp_ge_u32 s86, 0x10000
  s_cselect_b32 s34, 37748736, 0
  s_mov_b32 s23, s78
  buffer_load_dwordx4 v4, s[32:35], s23 offen nt lds
  s_add_u32 m0, m0, 0x400
  s_add_u32 s23, s23, 0x2000
  buffer_load_dwordx4 v5, s[32:35], s23 offen nt lds
  s_add_u32 m0, m0, 0x400
  s_add_u32 s23, s23, 0x2000
  buffer_load_dwordx4 v6, s[32:35], s23 offen nt lds
  s_add_u32 m0, m0, 0x400
  s_add_u32 s23, s23, 0x2000
  buffer_load_dwordx4 v7, s[32:35], s23 offen nt lds
  s_add_u32 m0, m0, 0x400
  s_mov_b32 s40, s16
  s_and_b32 s41, s17, 0xffff
  s_mov_b32 s42, 65536
  s_mov_b32 s43, 0x20000
  s_lshl_b32 s15, s3, 6
  v_lshlrev_b32 v26, 8, v2
  v_and_b32 v27, 0xf0, v4
  v_xor_b32 v27, s15, v27
  v_or_b32 v26, v26, v27
  s_lshl_b32 s15, s7, 2
  s_add_u32 s15, s15, s3
  s_lshl_b32 s15, s15, 13
  s_lshl_b32 s19, s4, 10
  s_add_u32 s15, s15, s19
  s_mov_b32 s19, m0
  s_lshl_b32 s1, s3, 10
  s_add_u32 m0, s1, 131072
  s_nop 0
  buffer_load_dwordx4 v26, s[40:43], s15 offen lds
  s_add_u32 m0, m0, 0x1000
  s_add_u32 s15, s15, 32768
  s_cmp_lg_u32 s6, 0
  s_cselect_b32 s42, 65536, 0
  buffer_load_dwordx4 v26, s[40:43], s15 offen lds
  s_mov_b32 m0, s19
  s_nop 0
  s_cmp_ge_u32 s87, 0x10000
  s_cselect_b32 s34, 37748736, 0
  s_mov_b32 s23, s79
  buffer_load_dwordx4 v4, s[32:35], s23 offen nt lds
  s_add_u32 m0, m0, 0x400
  s_add_u32 s23, s23, 0x2000
  buffer_load_dwordx4 v5, s[32:35], s23 offen nt lds
  s_add_u32 m0, m0, 0x400
  s_add_u32 s23, s23, 0x2000
  buffer_load_dwordx4 v6, s[32:35], s23 offen nt lds
  s_add_u32 m0, m0, 0x400
  s_add_u32 s23, s23, 0x2000
  buffer_load_dwordx4 v7, s[32:35], s23 offen nt lds
  s_add_u32 m0, m0, 0x400
  s_cmp_ge_u32 s88, 0x10000
  s_cselect_b32 s34, 37748736, 0
  s_mov_b32 s23, s80
  buffer_load_dwordx4 v4, s[32:35], s23 offen nt lds
  s_add_u32 m0, m0, 0x400
  s_add_u32 s23, s23, 0x2000
  buffer_load_dwordx4 v5, s[32:35], s23 offen nt lds
  s_add_u32 m0, m0, 0x400
  s_add_u32 s23, s23, 0x2000
  buffer_load_dwordx4 v6, s[32:35], s23 offen nt lds
  s_add_u32 m0, m0, 0x400
  s_add_u32 s23, s23, 0x2000
  buffer_load_dwordx4 v7, s[32:35], s23 offen nt lds
  s_add_u32 m0, m0, 0x400
L_loads_done:
  buffer_load_dword v62, v62, s[44:47], 0 offen
  s_mov_b32 s36, s20
  s_and_b32 s37, s21, 0xffff
  s_mov_b32 s38, 37748736
  s_mov_b32 s39, 0x20000
  v_mov_b32 v58, 0
  s_mov_b64 exec, 1
  buffer_load_dword v59, v58, s[36:39], s78 offen
  s_mov_b32 s52, s30
  s_and_b32 s53, s31, 0xffff
  s_mov_b32 s54, 4329472
  s_mov_b32 s55, 0x20000
  s_mov_b32 s56, s26
  s_and_b32 s57, s27, 0xffff
  s_mov_b32 s58, 65536
  s_mov_b32 s59, 0x20000
  s_lshl_b32 s15, s4, 3
  s_mul_i32 s15, s15, 67584
  buffer_load_dword v59, v58, s[52:55], s15 offen
  buffer_load_dword v59, v58, s[56:59], 0 offen
  global_load_dword v59, v58, s[28:29]
  s_mov_b64 exec, -1
  s_mov_b32 s15, 0x10000
  v_cmp_le_u32 vcc, s15, v20
  s_nop 1
  s_and_b32 s1, vcc_lo, 0xff
  s_bcnt1_i32_b32 s1, s1
  s_mov_b32 s36, s20
  s_and_b32 s37, s21, 0xffff
  s_mov_b32 s38, 37748736
  s_mov_b32 s39, 0x20000
  s_mov_b32 s52, s30
  s_and_b32 s53, s31, 0xffff
  s_mov_b32 s54, 4329472
  s_mov_b32 s55, 0x20000
  s_mov_b32 s56, s26
  s_and_b32 s57, s27, 0xffff
  s_mov_b32 s58, 65536
  s_mov_b32 s59, 0x20000
  s_mov_b64 s[48:49], s[30:31]
  v_add_u32 v26, 0, v2
  v_xor_b32 v26, v26, v3
  v_lshlrev_b32 v26, 4, v26
  v_lshl_add_u32 v26, v3, 8, v26
  v_add_u32 v8, s77, v26
  v_add_u32 v26, 4, v2
  v_xor_b32 v26, v26, v3
  v_lshlrev_b32 v26, 4, v26
  v_lshl_add_u32 v26, v3, 8, v26
  v_add_u32 v9, s77, v26
  v_add_u32 v26, 8, v2
  v_xor_b32 v26, v26, v3
  v_lshlrev_b32 v26, 4, v26
  v_lshl_add_u32 v26, v3, 8, v26
  v_add_u32 v10, s77, v26
  v_add_u32 v26, 12, v2
  v_xor_b32 v26, v26, v3
  v_lshlrev_b32 v26, 4, v26
  v_lshl_add_u32 v26, v3, 8, v26
  v_add_u32 v11, s77, v26
  s_sub_u32 s15, 131072, s77
  v_add_u32 v36, s15, v8
  v_add_u32 v37, s15, v9
  v_add_u32 v38, s15, v10
  v_add_u32 v39, s15, v11
  v_lshlrev_b32 v26, 4, v3
  v_lshl_add_u32 v12, v2, 13, v26
  v_add_u32 v13, 4096, v12
  v_mov_b32 v18, 0xf149f2ca
  v_lshrrev_b32 v34, 2, v3
  s_lshl_b32 s15, s7, 2
  s_add_u32 s15, s15, 16
  v_add_u32 v26, s15, v34
  v_lshlrev_b32_e64 v16, v26, 1
  v_lshlrev_b32 v17, 4, v16
  s_mov_b32 s47, 3
  s_waitcnt lgkmcnt(0)
  s_min_i32 s60, s60, 4096
  v_writelane_b32 v21, s60, 32
  s_min_i32 s61, s61, 4096
  v_writelane_b32 v21, s61, 33
  s_min_i32 s62, s62, 4096
  v_writelane_b32 v21, s62, 34
  s_min_i32 s63, s63, 4096
  v_writelane_b32 v21, s63, 35
  s_min_i32 s64, s64, 4096
  v_writelane_b32 v21, s64, 36
  s_min_i32 s65, s65, 4096
  v_writelane_b32 v21, s65, 37
  s_min_i32 s66, s66, 4096
  v_writelane_b32 v21, s66, 38
  s_min_i32 s67, s67, 4096
  v_writelane_b32 v21, s67, 39
  s_lshl_b32 s15, s7, 2
  s_add_u32 s15, s15, 32
  v_add_u32 v26, s15, v34
  v_lshlrev_b32 v26, 2, v26
  v_add_u32 v27, 16, v26
  ds_bpermute_b32 v14, v26, v21
  ds_bpermute_b32 v15, v27, v21
  s_mov_b32 s16, 0x3e0293ee
  s_waitcnt vmcnt(13)
  s_barrier
  ds_read_b128 a[72:75], v36 offset:0
  ds_read_b128 a[76:79], v37 offset:0
  ds_read_b128 a[80:83], v38 offset:0
  ds_read_b128 a[84:87], v39 offset:0
  ds_read_b128 a[88:91], v36 offset:4096
  ds_read_b128 a[92:95], v37 offset:4096
  ds_read_b128 a[96:99], v38 offset:4096
  ds_read_b128 a[100:103], v39 offset:4096
  v_lshlrev_b32 v26, 2, v2
  s_waitcnt lgkmcnt(0)
  v_sub_u32 v14, v14, v26
  v_sub_u32 v15, v15, v26
L_setup_done:
  s_cmp_eq_u32 s6, 0
  s_cbranch_scc1 L_narrow
  v_mov_b32 v24, v18
  v_mov_b32 v25, v18
  s_waitcnt vmcnt(15)
  ds_read_b128 a[104:107], v8 offset:0
  ds_read_b128 a[108:111], v9 offset:0
  ds_read_b128 a[112:115], v10 offset:0
  ds_read_b128 a[116:119], v11 offset:0
  s_cmp_ge_u32 s89, 0x10000
  s_cselect_b32 s34, 37748736, 0
  s_mov_b32 s23, s81
  buffer_load_dwordx4 v4, s[32:35], s23 offen nt lds
  s_add_u32 m0, m0, 0x400
  s_add_u32 s23, s23, 0x2000
  buffer_load_dwordx4 v5, s[32:35], s23 offen nt lds
  s_add_u32 m0, m0, 0x400
  s_add_u32 s23, s23, 0x2000
  buffer_load_dwordx4 v6, s[32:35], s23 offen nt lds
  s_add_u32 m0, m0, 0x400
  s_add_u32 s23, s23, 0x2000
  buffer_load_dwordx4 v7, s[32:35], s23 offen nt lds
  s_add_u32 m0, m0, 0x400
  s_waitcnt lgkmcnt(0)
  v_mfma_f32_16x16x32_bf16 v[64:67], a[104:107], a[72:75], 0
  v_mfma_f32_16x16x32_bf16 v[64:67], a[108:111], a[76:79], v[64:67]
  v_mfma_f32_16x16x32_bf16 v[64:67], a[112:115], a[80:83], v[64:67]
  v_mfma_f32_16x16x32_bf16 v[64:67], a[116:119], a[84:87], v[64:67]
  v_mfma_f32_16x16x32_bf16 v[68:71], a[104:107], a[88:91], 0
  v_mfma_f32_16x16x32_bf16 v[68:71], a[108:111], a[92:95], v[68:71]
  v_mfma_f32_16x16x32_bf16 v[68:71], a[112:115], a[96:99], v[68:71]
  v_mfma_f32_16x16x32_bf16 v[68:71], a[116:119], a[100:103], v[68:71]
  s_bitcmp1_b32 s47, 1
  s_cbranch_scc1 L_setupB
L_sbret_2:
  s_waitcnt vmcnt(13)
  ds_read_b128 a[120:123], v8 offset:4096
  ds_read_b128 a[124:127], v9 offset:4096
  ds_read_b128 a[128:131], v10 offset:4096
  ds_read_b128 a[132:135], v11 offset:4096
  s_cmp_ge_u32 s90, 0x10000
  s_cselect_b32 s34, 37748736, 0
  s_mov_b32 s23, s82
  buffer_load_dwordx4 v4, s[32:35], s23 offen nt lds
  s_add_u32 m0, m0, 0x400
  s_add_u32 s23, s23, 0x2000
  buffer_load_dwordx4 v5, s[32:35], s23 offen nt lds
  s_add_u32 m0, m0, 0x400
  s_add_u32 s23, s23, 0x2000
  buffer_load_dwordx4 v6, s[32:35], s23 offen nt lds
  s_add_u32 m0, m0, 0x400
  s_add_u32 s23, s23, 0x2000
  buffer_load_dwordx4 v7, s[32:35], s23 offen nt lds
  s_add_u32 m0, m0, 0x400
  s_and_b32 s15, s86, 0xffff
  v_and_b32 v26, s86, v16
  v_cmp_ne_u32 vcc, 0, v26
  v_subrev_u32 v27, s15, v14
  s_nop 0
  v_cndmask_b32 v27, -1, v27, vcc
  v_cmp_lt_i32_e64 s[94:95], 0, v27
  v_cmp_lt_i32_e64 s[96:97], 1, v27
  v_cmp_lt_i32_e64 s[98:99], 2, v27
  v_cmp_lt_i32_e64 s[100:101], 3, v27
  v_cndmask_b32_e64 v64, v18, v64, s[94:95]
  v_cndmask_b32_e64 v65, v18, v65, s[96:97]
  v_cndmask_b32_e64 v66, v18, v66, s[98:99]
  v_cndmask_b32_e64 v67, v18, v67, s[100:101]
  v_max3_f32 v24, v64, v65, v24
  v_max3_f32 v24, v66, v67, v24
  v_and_b32 v26, s86, v17
  v_cmp_ne_u32 vcc, 0, v26
  v_subrev_u32 v27, s15, v15
  s_nop 0
  v_cndmask_b32 v27, -1, v27, vcc
  v_cmp_lt_i32_e64 s[94:95], 0, v27
  v_cmp_lt_i32_e64 s[96:97], 1, v27
  v_cmp_lt_i32_e64 s[98:99], 2, v27
  v_cmp_lt_i32_e64 s[100:101], 3, v27
  v_cndmask_b32_e64 v68, v18, v68, s[94:95]
  v_cndmask_b32_e64 v69, v18, v69, s[96:97]
  v_cndmask_b32_e64 v70, v18, v70, s[98:99]
  v_cndmask_b32_e64 v71, v18, v71, s[100:101]
  v_max3_f32 v25, v68, v69, v25
  v_max3_f32 v25, v70, v71, v25
  s_waitcnt lgkmcnt(0)
  v_mfma_f32_16x16x32_bf16 v[72:75], a[120:123], a[72:75], 0
  v_mfma_f32_16x16x32_bf16 v[72:75], a[124:127], a[76:79], v[72:75]
  v_mfma_f32_16x16x32_bf16 v[72:75], a[128:131], a[80:83], v[72:75]
  v_mfma_f32_16x16x32_bf16 v[72:75], a[132:135], a[84:87], v[72:75]
  v_mfma_f32_16x16x32_bf16 v[76:79], a[120:123], a[88:91], 0
  v_mfma_f32_16x16x32_bf16 v[76:79], a[124:127], a[92:95], v[76:79]
  v_mfma_f32_16x16x32_bf16 v[76:79], a[128:131], a[96:99], v[76:79]
  v_mfma_f32_16x16x32_bf16 v[76:79], a[132:135], a[100:103], v[76:79]
  s_cmp_le_u32 s1, 2
  s_cbranch_scc1 L_drain2_2
  s_waitcnt vmcnt(13)
  ds_read_b128 a[104:107], v8 offset:8192
  ds_read_b128 a[108:111], v9 offset:8192
  ds_read_b128 a[112:115], v10 offset:8192
  ds_read_b128 a[116:119], v11 offset:8192
  s_cmp_ge_u32 s91, 0x10000
  s_cselect_b32 s34, 37748736, 0
  s_mov_b32 s23, s83
  buffer_load_dwordx4 v4, s[32:35], s23 offen nt lds
  s_add_u32 m0, m0, 0x400
  s_add_u32 s23, s23, 0x2000
  buffer_load_dwordx4 v5, s[32:35], s23 offen nt lds
  s_add_u32 m0, m0, 0x400
  s_add_u32 s23, s23, 0x2000
  buffer_load_dwordx4 v6, s[32:35], s23 offen nt lds
  s_add_u32 m0, m0, 0x400
  s_add_u32 s23, s23, 0x2000
  buffer_load_dwordx4 v7, s[32:35], s23 offen nt lds
  s_add_u32 m0, m0, 0x400
  s_and_b32 s15, s87, 0xffff
  v_and_b32 v26, s87, v16
  v_cmp_ne_u32 vcc, 0, v26
  v_subrev_u32 v27, s15, v14
  s_nop 0
  v_cndmask_b32 v27, -1, v27, vcc
  v_cmp_lt_i32_e64 s[94:95], 0, v27
  v_cmp_lt_i32_e64 s[96:97], 1, v27
  v_cmp_lt_i32_e64 s[98:99], 2, v27
  v_cmp_lt_i32_e64 s[100:101], 3, v27
  v_cndmask_b32_e64 v72, v18, v72, s[94:95]
  v_cndmask_b32_e64 v73, v18, v73, s[96:97]
  v_cndmask_b32_e64 v74, v18, v74, s[98:99]
  v_cndmask_b32_e64 v75, v18, v75, s[100:101]
  v_max3_f32 v24, v72, v73, v24
  v_max3_f32 v24, v74, v75, v24
  v_and_b32 v26, s87, v17
  v_cmp_ne_u32 vcc, 0, v26
  v_subrev_u32 v27, s15, v15
  s_nop 0
  v_cndmask_b32 v27, -1, v27, vcc
  v_cmp_lt_i32_e64 s[94:95], 0, v27
  v_cmp_lt_i32_e64 s[96:97], 1, v27
  v_cmp_lt_i32_e64 s[98:99], 2, v27
  v_cmp_lt_i32_e64 s[100:101], 3, v27
  v_cndmask_b32_e64 v76, v18, v76, s[94:95]
  v_cndmask_b32_e64 v77, v18, v77, s[96:97]
  v_cndmask_b32_e64 v78, v18, v78, s[98:99]
  v_cndmask_b32_e64 v79, v18, v79, s[100:101]
  v_max3_f32 v25, v76, v77, v25
  v_max3_f32 v25, v78, v79, v25
  s_waitcnt lgkmcnt(0)
  v_mfma_f32_16x16x32_bf16 v[80:83], a[104:107], a[72:75], 0
  v_mfma_f32_16x16x32_bf16 v[80:83], a[108:111], a[76:79], v[80:83]
  v_mfma_f32_16x16x32_bf16 v[80:83], a[112:115], a[80:83], v[80:83]
  v_mfma_f32_16x16x32_bf16 v[80:83], a[116:119], a[84:87], v[80:83]
  v_mfma_f32_16x16x32_bf16 v[84:87], a[104:107], a[88:91], 0
  v_mfma_f32_16x16x32_bf16 v[84:87], a[108:111], a[92:95], v[84:87]
  v_mfma_f32_16x16x32_bf16 v[84:87], a[112:115], a[96:99], v[84:87]
  v_mfma_f32_16x16x32_bf16 v[84:87], a[116:119], a[100:103], v[84:87]
  s_waitcnt vmcnt(8)
  ds_read_b128 a[120:123], v8 offset:12288
  ds_read_b128 a[124:127], v9 offset:12288
  ds_read_b128 a[128:131], v10 offset:12288
  ds_read_b128 a[132:135], v11 offset:12288
  s_cmp_ge_u32 s92, 0x10000
  s_cselect_b32 s34, 37748736, 0
  s_mov_b32 s23, s84
  buffer_load_dwordx4 v4, s[32:35], s23 offen nt lds
  s_add_u32 m0, m0, 0x400
  s_add_u32 s23, s23, 0x2000
  buffer_load_dwordx4 v5, s[32:35], s23 offen nt lds
  s_add_u32 m0, m0, 0x400
  s_add_u32 s23, s23, 0x2000
  buffer_load_dwordx4 v6, s[32:35], s23 offen nt lds
  s_add_u32 m0, m0, 0x400
  s_add_u32 s23, s23, 0x2000
  buffer_load_dwordx4 v7, s[32:35], s23 offen nt lds
  s_add_u32 m0, m0, 0x400
  s_and_b32 s15, s88, 0xffff
  v_and_b32 v26, s88, v16
  v_cmp_ne_u32 vcc, 0, v26
  v_subrev_u32 v27, s15, v14
  s_nop 0
  v_cndmask_b32 v27, -1, v27, vcc
  v_cmp_lt_i32_e64 s[94:95], 0, v27
  v_cmp_lt_i32_e64 s[96:97], 1, v27
  v_cmp_lt_i32_e64 s[98:99], 2, v27
  v_cmp_lt_i32_e64 s[100:101], 3, v27
  v_cndmask_b32_e64 v80, v18, v80, s[94:95]
  v_cndmask_b32_e64 v81, v18, v81, s[96:97]
  v_cndmask_b32_e64 v82, v18, v82, s[98:99]
  v_cndmask_b32_e64 v83, v18, v83, s[100:101]
  v_max3_f32 v24, v80, v81, v24
  v_max3_f32 v24, v82, v83, v24
  v_and_b32 v26, s88, v17
  v_cmp_ne_u32 vcc, 0, v26
  v_subrev_u32 v27, s15, v15
  s_nop 0
  v_cndmask_b32 v27, -1, v27, vcc
  v_cmp_lt_i32_e64 s[94:95], 0, v27
  v_cmp_lt_i32_e64 s[96:97], 1, v27
  v_cmp_lt_i32_e64 s[98:99], 2, v27
  v_cmp_lt_i32_e64 s[100:101], 3, v27
  v_cndmask_b32_e64 v84, v18, v84, s[94:95]
  v_cndmask_b32_e64 v85, v18, v85, s[96:97]
  v_cndmask_b32_e64 v86, v18, v86, s[98:99]
  v_cndmask_b32_e64 v87, v18, v87, s[100:101]
  v_max3_f32 v25, v84, v85, v25
  v_max3_f32 v25, v86, v87, v25
  s_waitcnt lgkmcnt(0)
  v_mfma_f32_16x16x32_bf16 v[88:91], a[120:123], a[72:75], 0
  v_mfma_f32_16x16x32_bf16 v[88:91], a[124:127], a[76:79], v[88:91]
  v_mfma_f32_16x16x32_bf16 v[88:91], a[128:131], a[80:83], v[88:91]
  v_mfma_f32_16x16x32_bf16 v[88:91], a[132:135], a[84:87], v[88:91]
  v_mfma_f32_16x16x32_bf16 v[92:95], a[120:123], a[88:91], 0
  v_mfma_f32_16x16x32_bf16 v[92:95], a[124:127], a[92:95], v[92:95]
  v_mfma_f32_16x16x32_bf16 v[92:95], a[128:131], a[96:99], v[92:95]
  v_mfma_f32_16x16x32_bf16 v[92:95], a[132:135], a[100:103], v[92:95]
  s_cmp_le_u32 s1, 4
  s_cbranch_scc1 L_drain4_2
  s_waitcnt vmcnt(8)
  ds_read_b128 a[104:107], v8 offset:16384
  ds_read_b128 a[108:111], v9 offset:16384
  ds_read_b128 a[112:115], v10 offset:16384
  ds_read_b128 a[116:119], v11 offset:16384
  s_cmp_ge_u32 s93, 0x10000
  s_cselect_b32 s34, 37748736, 0
  s_mov_b32 s23, s85
  buffer_load_dwordx4 v4, s[32:35], s23 offen nt lds
  s_add_u32 m0, m0, 0x400
  s_add_u32 s23, s23, 0x2000
  buffer_load_dwordx4 v5, s[32:35], s23 offen nt lds
  s_add_u32 m0, m0, 0x400
  s_add_u32 s23, s23, 0x2000
  buffer_load_dwordx4 v6, s[32:35], s23 offen nt lds
  s_add_u32 m0, m0, 0x400
  s_add_u32 s23, s23, 0x2000
  buffer_load_dwordx4 v7, s[32:35], s23 offen nt lds
  s_add_u32 m0, m0, 0x400
  s_and_b32 s15, s89, 0xffff
  v_and_b32 v26, s89, v16
  v_cmp_ne_u32 vcc, 0, v26
  v_subrev_u32 v27, s15, v14
  s_nop 0
  v_cndmask_b32 v27, -1, v27, vcc
  v_cmp_lt_i32_e64 s[94:95], 0, v27
  v_cmp_lt_i32_e64 s[96:97], 1, v27
  v_cmp_lt_i32_e64 s[98:99], 2, v27
  v_cmp_lt_i32_e64 s[100:101], 3, v27
  v_cndmask_b32_e64 v88, v18, v88, s[94:95]
  v_cndmask_b32_e64 v89, v18, v89, s[96:97]
  v_cndmask_b32_e64 v90, v18, v90, s[98:99]
  v_cndmask_b32_e64 v91, v18, v91, s[100:101]
  v_max3_f32 v24, v88, v89, v24
  v_max3_f32 v24, v90, v91, v24
  v_and_b32 v26, s89, v17
  v_cmp_ne_u32 vcc, 0, v26
  v_subrev_u32 v27, s15, v15
  s_nop 0
  v_cndmask_b32 v27, -1, v27, vcc
  v_cmp_lt_i32_e64 s[94:95], 0, v27
  v_cmp_lt_i32_e64 s[96:97], 1, v27
  v_cmp_lt_i32_e64 s[98:99], 2, v27
  v_cmp_lt_i32_e64 s[100:101], 3, v27
  v_cndmask_b32_e64 v92, v18, v92, s[94:95]
  v_cndmask_b32_e64 v93, v18, v93, s[96:97]
  v_cndmask_b32_e64 v94, v18, v94, s[98:99]
  v_cndmask_b32_e64 v95, v18, v95, s[100:101]
  v_max3_f32 v25, v92, v93, v25
  v_max3_f32 v25, v94, v95, v25
  s_waitcnt lgkmcnt(0)
  v_mfma_f32_16x16x32_bf16 v[96:99], a[104:107], a[72:75], 0
  v_mfma_f32_16x16x32_bf16 v[96:99], a[108:111], a[76:79], v[96:99]
  v_mfma_f32_16x16x32_bf16 v[96:99], a[112:115], a[80:83], v[96:99]
  v_mfma_f32_16x16x32_bf16 v[96:99], a[116:119], a[84:87], v[96:99]
  v_mfma_f32_16x16x32_bf16 v[100:103], a[104:107], a[88:91], 0
  v_mfma_f32_16x16x32_bf16 v[100:103], a[108:111], a[92:95], v[100:103]
  v_mfma_f32_16x16x32_bf16 v[100:103], a[112:115], a[96:99], v[100:103]
  v_mfma_f32_16x16x32_bf16 v[100:103], a[116:119], a[100:103], v[100:103]
  s_waitcnt vmcnt(8)
  ds_read_b128 a[120:123], v8 offset:20480
  ds_read_b128 a[124:127], v9 offset:20480
  ds_read_b128 a[128:131], v10 offset:20480
  ds_read_b128 a[132:135], v11 offset:20480
  s_cmp_ge_u32 s86, 0x10000
  s_cselect_b32 s38, 37748736, 0
  buffer_load_dwordx4 v[128:131], v12, s[36:39], s78 offen offset:0 nt
  buffer_load_dwordx4 v[132:135], v12, s[36:39], s78 offen offset:2048 nt
  buffer_load_dwordx4 v[136:139], v13, s[36:39], s78 offen offset:0 nt
  buffer_load_dwordx4 v[140:143], v13, s[36:39], s78 offen offset:2048 nt
  s_and_b32 s15, s90, 0xffff
  v_and_b32 v26, s90, v16
  v_cmp_ne_u32 vcc, 0, v26
  v_subrev_u32 v27, s15, v14
  s_nop 0
  v_cndmask_b32 v27, -1, v27, vcc
  v_cmp_lt_i32_e64 s[94:95], 0, v27
  v_cmp_lt_i32_e64 s[96:97], 1, v27
  v_cmp_lt_i32_e64 s[98:99], 2, v27
  v_cmp_lt_i32_e64 s[100:101], 3, v27
  v_cndmask_b32_e64 v96, v18, v96, s[94:95]
  v_cndmask_b32_e64 v97, v18, v97, s[96:97]
  v_cndmask_b32_e64 v98, v18, v98, s[98:99]
  v_cndmask_b32_e64 v99, v18, v99, s[100:101]
  v_max3_f32 v24, v96, v97, v24
  v_max3_f32 v24, v98, v99, v24
  v_and_b32 v26, s90, v17
  v_cmp_ne_u32 vcc, 0, v26
  v_subrev_u32 v27, s15, v15
  s_nop 0
  v_cndmask_b32 v27, -1, v27, vcc
  v_cmp_lt_i32_e64 s[94:95], 0, v27
  v_cmp_lt_i32_e64 s[96:97], 1, v27
  v_cmp_lt_i32_e64 s[98:99], 2, v27
  v_cmp_lt_i32_e64 s[100:101], 3, v27
  v_cndmask_b32_e64 v100, v18, v100, s[94:95]
  v_cndmask_b32_e64 v101, v18, v101, s[96:97]
  v_cndmask_b32_e64 v102, v18, v102, s[98:99]
  v_cndmask_b32_e64 v103, v18, v103, s[100:101]
  v_max3_f32 v25, v100, v101, v25
  v_max3_f32 v25, v102, v103, v25
  s_waitcnt lgkmcnt(0)
  v_mfma_f32_16x16x32_bf16 v[104:107], a[120:123], a[72:75], 0
  v_mfma_f32_16x16x32_bf16 v[104:107], a[124:127], a[76:79], v[104:107]
  v_mfma_f32_16x16x32_bf16 v[104:107], a[128:131], a[80:83], v[104:107]
  v_mfma_f32_16x16x32_bf16 v[104:107], a[132:135], a[84:87], v[104:107]
  v_mfma_f32_16x16x32_bf16 v[108:111], a[120:123], a[88:91], 0
  v_mfma_f32_16x16x32_bf16 v[108:111], a[124:127], a[92:95], v[108:111]
  v_mfma_f32_16x16x32_bf16 v[108:111], a[128:131], a[96:99], v[108:111]
  v_mfma_f32_16x16x32_bf16 v[108:111], a[132:135], a[100:103], v[108:111]
  s_cmp_le_u32 s1, 6
  s_cbranch_scc1 L_drain6_2
  s_waitcnt vmcnt(8)
  ds_read_b128 a[104:107], v8 offset:24576
  ds_read_b128 a[108:111], v9 offset:24576
  ds_read_b128 a[112:115], v10 offset:24576
  ds_read_b128 a[116:119], v11 offset:24576
  s_cmp_ge_u32 s87, 0x10000
  s_cselect_b32 s38, 37748736, 0
  buffer_load_dwordx4 v[144:147], v12, s[36:39], s79 offen offset:0 nt
  buffer_load_dwordx4 v[148:151], v12, s[36:39], s79 offen offset:2048 nt
  buffer_load_dwordx4 v[152:155], v13, s[36:39], s79 offen offset:0 nt
  buffer_load_dwordx4 v[156:159], v13, s[36:39], s79 offen offset:2048 nt
  s_and_b32 s15, s91, 0xffff
  v_and_b32 v26, s91, v16
  v_cmp_ne_u32 vcc, 0, v26
  v_subrev_u32 v27, s15, v14
  s_nop 0
  v_cndmask_b32 v27, -1, v27, vcc
  v_cmp_lt_i32_e64 s[94:95], 0, v27
  v_cmp_lt_i32_e64 s[96:97], 1, v27
  v_cmp_lt_i32_e64 s[98:99], 2, v27
  v_cmp_lt_i32_e64 s[100:101], 3, v27
  v_cndmask_b32_e64 v104, v18, v104, s[94:95]
  v_cndmask_b32_e64 v105, v18, v105, s[96:97]
  v_cndmask_b32_e64 v106, v18, v106, s[98:99]
  v_cndmask_b32_e64 v107, v18, v107, s[100:101]
  v_max3_f32 v24, v104, v105, v24
  v_max3_f32 v24, v106, v107, v24
  v_and_b32 v26, s91, v17
  v_cmp_ne_u32 vcc, 0, v26
  v_subrev_u32 v27, s15, v15
  s_nop 0
  v_cndmask_b32 v27, -1, v27, vcc
  v_cmp_lt_i32_e64 s[94:95], 0, v27
  v_cmp_lt_i32_e64 s[96:97], 1, v27
  v_cmp_lt_i32_e64 s[98:99], 2, v27
  v_cmp_lt_i32_e64 s[100:101], 3, v27
  v_cndmask_b32_e64 v108, v18, v108, s[94:95]
  v_cndmask_b32_e64 v109, v18, v109, s[96:97]
  v_cndmask_b32_e64 v110, v18, v110, s[98:99]
  v_cndmask_b32_e64 v111, v18, v111, s[100:101]
  v_max3_f32 v25, v108, v109, v25
  v_max3_f32 v25, v110, v111, v25
  s_waitcnt lgkmcnt(0)
  v_mfma_f32_16x16x32_bf16 v[112:115], a[104:107], a[72:75], 0
  v_mfma_f32_16x16x32_bf16 v[112:115], a[108:111], a[76:79], v[112:115]
  v_mfma_f32_16x16x32_bf16 v[112:115], a[112:115], a[80:83], v[112:115]
  v_mfma_f32_16x16x32_bf16 v[112:115], a[116:119], a[84:87], v[112:115]
  v_mfma_f32_16x16x32_bf16 v[116:119], a[104:107], a[88:91], 0
  v_mfma_f32_16x16x32_bf16 v[116:119], a[108:111], a[92:95], v[116:119]
  v_mfma_f32_16x16x32_bf16 v[116:119], a[112:115], a[96:99], v[116:119]
  v_mfma_f32_16x16x32_bf16 v[116:119], a[116:119], a[100:103], v[116:119]
  s_waitcnt vmcnt(8)
  ds_read_b128 a[120:123], v8 offset:28672
  ds_read_b128 a[124:127], v9 offset:28672
  ds_read_b128 a[128:131], v10 offset:28672
  ds_read_b128 a[132:135], v11 offset:28672
  s_cmp_ge_u32 s88, 0x10000
  s_cselect_b32 s38, 37748736, 0
  buffer_load_dwordx4 v[160:163], v12, s[36:39], s80 offen offset:0 nt
  buffer_load_dwordx4 v[164:167], v12, s[36:39], s80 offen offset:2048 nt
  buffer_load_dwordx4 v[168:171], v13, s[36:39], s80 offen offset:0 nt
  buffer_load_dwordx4 v[172:175], v13, s[36:39], s80 offen offset:2048 nt
  s_and_b32 s15, s92, 0xffff
  v_and_b32 v26, s92, v16
  v_cmp_ne_u32 vcc, 0, v26
  v_subrev_u32 v27, s15, v14
  s_nop 0
  v_cndmask_b32 v27, -1, v27, vcc
  v_cmp_lt_i32_e64 s[94:95], 0, v27
  v_cmp_lt_i32_e64 s[96:97], 1, v27
  v_cmp_lt_i32_e64 s[98:99], 2, v27
  v_cmp_lt_i32_e64 s[100:101], 3, v27
  v_cndmask_b32_e64 v112, v18, v112, s[94:95]
  v_cndmask_b32_e64 v113, v18, v113, s[96:97]
  v_cndmask_b32_e64 v114, v18, v114, s[98:99]
  v_cndmask_b32_e64 v115, v18, v115, s[100:101]
  v_max3_f32 v24, v112, v113, v24
  v_max3_f32 v24, v114, v115, v24
  v_and_b32 v26, s92, v17
  v_cmp_ne_u32 vcc, 0, v26
  v_subrev_u32 v27, s15, v15
  s_nop 0
  v_cndmask_b32 v27, -1, v27, vcc
  v_cmp_lt_i32_e64 s[94:95], 0, v27
  v_cmp_lt_i32_e64 s[96:97], 1, v27
  v_cmp_lt_i32_e64 s[98:99], 2, v27
  v_cmp_lt_i32_e64 s[100:101], 3, v27
  v_cndmask_b32_e64 v116, v18, v116, s[94:95]
  v_cndmask_b32_e64 v117, v18, v117, s[96:97]
  v_cndmask_b32_e64 v118, v18, v118, s[98:99]
  v_cndmask_b32_e64 v119, v18, v119, s[100:101]
  v_max3_f32 v25, v116, v117, v25
  v_max3_f32 v25, v118, v119, v25
  s_waitcnt lgkmcnt(0)
  v_mfma_f32_16x16x32_bf16 v[120:123], a[120:123], a[72:75], 0
  v_mfma_f32_16x16x32_bf16 v[120:123], a[124:127], a[76:79], v[120:123]
  v_mfma_f32_16x16x32_bf16 v[120:123], a[128:131], a[80:83], v[120:123]
  v_mfma_f32_16x16x32_bf16 v[120:123], a[132:135], a[84:87], v[120:123]
  v_mfma_f32_16x16x32_bf16 v[124:127], a[120:123], a[88:91], 0
  v_mfma_f32_16x16x32_bf16 v[124:127], a[124:127], a[92:95], v[124:127]
  v_mfma_f32_16x16x32_bf16 v[124:127], a[128:131], a[96:99], v[124:127]
  v_mfma_f32_16x16x32_bf16 v[124:127], a[132:135], a[100:103], v[124:127]
  s_cmp_ge_u32 s89, 0x10000
  s_cselect_b32 s38, 37748736, 0
  buffer_load_dwordx4 v[176:179], v12, s[36:39], s81 offen offset:0 nt
  buffer_load_dwordx4 v[180:183], v12, s[36:39], s81 offen offset:2048 nt
  buffer_load_dwordx4 v[184:187], v13, s[36:39], s81 offen offset:0 nt
  buffer_load_dwordx4 v[188:191], v13, s[36:39], s81 offen offset:2048 nt
  s_nop 1
  s_and_b32 s15, s93, 0xffff
  v_and_b32 v26, s93, v16
  v_cmp_ne_u32 vcc, 0, v26
  v_subrev_u32 v27, s15, v14
  s_nop 0
  v_cndmask_b32 v27, -1, v27, vcc
  v_cmp_lt_i32_e64 s[94:95], 0, v27
  v_cmp_lt_i32_e64 s[96:97], 1, v27
  v_cmp_lt_i32_e64 s[98:99], 2, v27
  v_cmp_lt_i32_e64 s[100:101], 3, v27
  v_cndmask_b32_e64 v120, v18, v120, s[94:95]
  v_cndmask_b32_e64 v121, v18, v121, s[96:97]
  v_cndmask_b32_e64 v122, v18, v122, s[98:99]
  v_cndmask_b32_e64 v123, v18, v123, s[100:101]
  v_max3_f32 v24, v120, v121, v24
  v_max3_f32 v24, v122, v123, v24
  v_and_b32 v26, s93, v17
  v_cmp_ne_u32 vcc, 0, v26
  v_subrev_u32 v27, s15, v15
  s_nop 0
  v_cndmask_b32 v27, -1, v27, vcc
  v_cmp_lt_i32_e64 s[94:95], 0, v27
  v_cmp_lt_i32_e64 s[96:97], 1, v27
  v_cmp_lt_i32_e64 s[98:99], 2, v27
  v_cmp_lt_i32_e64 s[100:101], 3, v27
  v_cndmask_b32_e64 v124, v18, v124, s[94:95]
  v_cndmask_b32_e64 v125, v18, v125, s[96:97]
  v_cndmask_b32_e64 v126, v18, v126, s[98:99]
  v_cndmask_b32_e64 v127, v18, v127, s[100:101]
  v_max3_f32 v25, v124, v125, v25
  v_max3_f32 v25, v126, v127, v25
L_join_2:
  s_bitcmp1_b32 s47, 0
  s_cbranch_scc0 L_valid_2
  s_mov_b32 s15, 0x10000
  v_cmp_le_u32_e64 s[94:95], s15, v20
  v_cmp_ne_u32 vcc, v62, v63
  s_mov_b32 s47, 0
  s_nop 0
  s_and_b64 vcc, vcc, s[94:95]
  s_cbranch_vccnz L_fix
L_valid_2:
  s_lshl_b32 s15, s4, 5
  s_load_dwordx8 s[64:71], s[48:49], s15
  v_mov_b32 v26, v24
  s_nop 1
  v_permlane16_swap_b32 v24, v26
  s_nop 0
  v_max_f32 v24, v24, v26
  v_mov_b32 v26, v24
  s_nop 1
  v_permlane32_swap_b32 v24, v26
  s_nop 0
  v_max_f32 v24, v24, v26
  v_mul_f32 v24, s16, v24
  v_max_f32 v24, v24, v22
  v_mov_b32 v26, v25
  s_nop 1
  v_permlane16_swap_b32 v25, v26
  s_nop 0
  v_max_f32 v25, v25, v26
  v_mov_b32 v26, v25
  s_nop 1
  v_permlane32_swap_b32 v25, v26
  s_nop 0
  v_max_f32 v25, v25, v26
  v_mul_f32 v25, s16, v25
  v_max_f32 v25, v25, v23
  s_cmp_eq_u32 s13, 0
  s_cbranch_scc1 L_norescale_1
  v_sub_f32 v26, v22, v24
  v_exp_f32 v26, v26
  s_nop 0
  v_accvgpr_read_b32 v27, a0
  v_mul_f32 v27, v27, v26
  v_accvgpr_write_b32 a0, v27
  v_accvgpr_read_b32 v27, a1
  v_mul_f32 v27, v27, v26
  v_accvgpr_write_b32 a1, v27
  v_accvgpr_read_b32 v27, a2
  v_mul_f32 v27, v27, v26
  v_accvgpr_write_b32 a2, v27
  v_accvgpr_read_b32 v27, a3
  v_mul_f32 v27, v27, v26
  v_accvgpr_write_b32 a3, v27
  v_accvgpr_read_b32 v27, a4
  v_mul_f32 v27, v27, v26
  v_accvgpr_write_b32 a4, v27
  v_accvgpr_read_b32 v27, a5
  v_mul_f32 v27, v27, v26
  v_accvgpr_write_b32 a5, v27
  v_accvgpr_read_b32 v27, a6
  v_mul_f32 v27, v27, v26
  v_accvgpr_write_b32 a6, v27
  v_accvgpr_read_b32 v27, a7
  v_mul_f32 v27, v27, v26
  v_accvgpr_write_b32 a7, v27
  v_accvgpr_read_b32 v27, a8
  v_mul_f32 v27, v27, v26
  v_accvgpr_write_b32 a8, v27
  v_accvgpr_read_b32 v27, a9
  v_mul_f32 v27, v27, v26
  v_accvgpr_write_b32 a9, v27
  v_accvgpr_read_b32 v27, a10
  v_mul_f32 v27, v27, v26
  v_accvgpr_write_b32 a10, v27
  v_accvgpr_read_b32 v27, a11
  v_mul_f32 v27, v27, v26
  v_accvgpr_write_b32 a11, v27
  v_accvgpr_read_b32 v27, a12
  v_mul_f32 v27, v27, v26
  v_accvgpr_write_b32 a12, v27
  v_accvgpr_read_b32 v27, a13
  v_mul_f32 v27, v27, v26
  v_accvgpr_write_b32 a13, v27
  v_accvgpr_read_b32 v27, a14
  v_mul_f32 v27, v27, v26
  v_accvgpr_write_b32 a14, v27
  v_accvgpr_read_b32 v27, a15
  v_mul_f32 v27, v27, v26
  v_accvgpr_write_b32 a15, v27
  v_accvgpr_read_b32 v27, a16
  v_mul_f32 v27, v27, v26
  v_accvgpr_write_b32 a16, v27
  v_accvgpr_read_b32 v27, a17
  v_mul_f32 v27, v27, v26
  v_accvgpr_write_b32 a17, v27
  v_accvgpr_read_b32 v27, a18
  v_mul_f32 v27, v27, v26
  v_accvgpr_write_b32 a18, v27
  v_accvgpr_read_b32 v27, a19
  v_mul_f32 v27, v27, v26
  v_accvgpr_write_b32 a19, v27
  v_accvgpr_read_b32 v27, a20
  v_mul_f32 v27, v27, v26
  v_accvgpr_write_b32 a20, v27
  v_accvgpr_read_b32 v27, a21
  v_mul_f32 v27, v27, v26
  v_accvgpr_write_b32 a21, v27
  v_accvgpr_read_b32 v27, a22
  v_mul_f32 v27, v27, v26
  v_accvgpr_write_b32 a22, v27
  v_accvgpr_read_b32 v27, a23
  v_mul_f32 v27, v27, v26
  v_accvgpr_write_b32 a23, v27
  v_accvgpr_read_b32 v27, a24
  v_mul_f32 v27, v27, v26
  v_accvgpr_write_b32 a24, v27
  v_accvgpr_read_b32 v27, a25
  v_mul_f32 v27, v27, v26
  v_accvgpr_write_b32 a25, v27
  v_accvgpr_read_b32 v27, a26
  v_mul_f32 v27, v27, v26
  v_accvgpr_write_b32 a26, v27
  v_accvgpr_read_b32 v27, a27
  v_mul_f32 v27, v27, v26
  v_accvgpr_write_b32 a27, v27
  v_accvgpr_read_b32 v27, a28
  v_mul_f32 v27, v27, v26
  v_accvgpr_write_b32 a28, v27
  v_accvgpr_read_b32 v27, a29
  v_mul_f32 v27, v27, v26
  v_accvgpr_write_b32 a29, v27
  v_accvgpr_read_b32 v27, a30
  v_mul_f32 v27, v27, v26
  v_accvgpr_write_b32 a30, v27
  v_accvgpr_read_b32 v27, a31
  v_mul_f32 v27, v27, v26
  v_accvgpr_write_b32 a31, v27
  v_accvgpr_read_b32 v27, a64
  v_mul_f32 v27, v27, v26
  v_accvgpr_write_b32 a64, v27
  v_accvgpr_read_b32 v27, a65
  v_mul_f32 v27, v27, v26
  v_accvgpr_write_b32 a65, v27
  v_accvgpr_read_b32 v27, a66
  v_mul_f32 v27, v27, v26
  v_accvgpr_write_b32 a66, v27
  v_accvgpr_read_b32 v27, a67
  v_mul_f32 v27, v27, v26
  v_accvgpr_write_b32 a67, v27
  v_sub_f32 v26, v23, v25
  v_exp_f32 v26, v26
  s_nop 0
  v_accvgpr_read_b32 v27, a32
  v_mul_f32 v27, v27, v26
  v_accvgpr_write_b32 a32, v27
  v_accvgpr_read_b32 v27, a33
  v_mul_f32 v27, v27, v26
  v_accvgpr_write_b32 a33, v27
  v_accvgpr_read_b32 v27, a34
  v_mul_f32 v27, v27, v26
  v_accvgpr_write_b32 a34, v27
  v_accvgpr_read_b32 v27, a35
  v_mul_f32 v27, v27, v26
  v_accvgpr_write_b32 a35, v27
  v_accvgpr_read_b32 v27, a36
  v_mul_f32 v27, v27, v26
  v_accvgpr_write_b32 a36, v27
  v_accvgpr_read_b32 v27, a37
  v_mul_f32 v27, v27, v26
  v_accvgpr_write_b32 a37, v27
  v_accvgpr_read_b32 v27, a38
  v_mul_f32 v27, v27, v26
  v_accvgpr_write_b32 a38, v27
  v_accvgpr_read_b32 v27, a39
  v_mul_f32 v27, v27, v26
  v_accvgpr_write_b32 a39, v27
  v_accvgpr_read_b32 v27, a40
  v_mul_f32 v27, v27, v26
  v_accvgpr_write_b32 a40, v27
  v_accvgpr_read_b32 v27, a41
  v_mul_f32 v27, v27, v26
  v_accvgpr_write_b32 a41, v27
  v_accvgpr_read_b32 v27, a42
  v_mul_f32 v27, v27, v26
  v_accvgpr_write_b32 a42, v27
  v_accvgpr_read_b32 v27, a43
  v_mul_f32 v27, v27, v26
  v_accvgpr_write_b32 a43, v27
  v_accvgpr_read_b32 v27, a44
  v_mul_f32 v27, v27, v26
  v_accvgpr_write_b32 a44, v27
  v_accvgpr_read_b32 v27, a45
  v_mul_f32 v27, v27, v26
  v_accvgpr_write_b32 a45, v27
  v_accvgpr_read_b32 v27, a46
  v_mul_f32 v27, v27, v26
  v_accvgpr_write_b32 a46, v27
  v_accvgpr_read_b32 v27, a47
  v_mul_f32 v27, v27, v26
  v_accvgpr_write_b32 a47, v27
  v_accvgpr_read_b32 v27, a48
  v_mul_f32 v27, v27, v26
  v_accvgpr_write_b32 a48, v27
  v_accvgpr_read_b32 v27, a49
  v_mul_f32 v27, v27, v26
  v_accvgpr_write_b32 a49, v27
  v_accvgpr_read_b32 v27, a50
  v_mul_f32 v27, v27, v26
  v_accvgpr_write_b32 a50, v27
  v_accvgpr_read_b32 v27, a51
  v_mul_f32 v27, v27, v26
  v_accvgpr_write_b32 a51, v27
  v_accvgpr_read_b32 v27, a52
  v_mul_f32 v27, v27, v26
  v_accvgpr_write_b32 a52, v27
  v_accvgpr_read_b32 v27, a53
  v_mul_f32 v27, v27, v26
  v_accvgpr_write_b32 a53, v27
  v_accvgpr_read_b32 v27, a54
  v_mul_f32 v27, v27, v26
  v_accvgpr_write_b32 a54, v27
  v_accvgpr_read_b32 v27, a55
  v_mul_f32 v27, v27, v26
  v_accvgpr_write_b32 a55, v27
  v_accvgpr_read_b32 v27, a56
  v_mul_f32 v27, v27, v26
  v_accvgpr_write_b32 a56, v27
  v_accvgpr_read_b32 v27, a57
  v_mul_f32 v27, v27, v26
  v_accvgpr_write_b32 a57, v27
  v_accvgpr_read_b32 v27, a58
  v_mul_f32 v27, v27, v26
  v_accvgpr_write_b32 a58, v27
  v_accvgpr_read_b32 v27, a59
  v_mul_f32 v27, v27, v26
  v_accvgpr_write_b32 a59, v27
  v_accvgpr_read_b32 v27, a60
  v_mul_f32 v27, v27, v26
  v_accvgpr_write_b32 a60, v27
  v_accvgpr_read_b32 v27, a61
  v_mul_f32 v27, v27, v26
  v_accvgpr_write_b32 a61, v27
  v_accvgpr_read_b32 v27, a62
  v_mul_f32 v27, v27, v26
  v_accvgpr_write_b32 a62, v27
  v_accvgpr_read_b32 v27, a63
  v_mul_f32 v27, v27, v26
  v_accvgpr_write_b32 a63, v27
  v_accvgpr_read_b32 v27, a68
  v_mul_f32 v27, v27, v26
  v_accvgpr_write_b32 a68, v27
  v_accvgpr_read_b32 v27, a69
  v_mul_f32 v27, v27, v26
  v_accvgpr_write_b32 a69, v27
  v_accvgpr_read_b32 v27, a70
  v_mul_f32 v27, v27, v26
  v_accvgpr_write_b32 a70, v27
  v_accvgpr_read_b32 v27, a71
  v_mul_f32 v27, v27, v26
  v_accvgpr_write_b32 a71, v27
L_norescale_1:
  v_mov_b32 v22, v24
  v_mov_b32 v26, 0xee013f39
  v_cmp_lt_f32 vcc, v24, v26
  s_nop 1
  v_cndmask_b32_e64 v24, v24, 0, vcc
  v_mov_b32 v23, v25
  v_mov_b32 v26, 0xee013f39
  v_cmp_lt_f32 vcc, v25, v26
  s_nop 1
  v_cndmask_b32_e64 v25, v25, 0, vcc
  s_cmp_ge_u32 s90, 0x10000
  s_cselect_b32 s38, 37748736, 0
  buffer_load_dwordx4 v[192:195], v12, s[36:39], s82 offen offset:0 nt
  buffer_load_dwordx4 v[196:199], v12, s[36:39], s82 offen offset:2048 nt
  buffer_load_dwordx4 v[200:203], v13, s[36:39], s82 offen offset:0 nt
  buffer_load_dwordx4 v[204:207], v13, s[36:39], s82 offen offset:2048 nt
  v_fma_f32 v64, v64, s16, -v24
  v_fma_f32 v65, v65, s16, -v24
  v_fma_f32 v66, v66, s16, -v24
  v_fma_f32 v67, v67, s16, -v24
  v_exp_f32 v64, v64
  v_exp_f32 v65, v65
  v_exp_f32 v66, v66
  v_exp_f32 v67, v67
  v_fma_f32 v72, v72, s16, -v24
  v_fma_f32 v73, v73, s16, -v24
  v_fma_f32 v74, v74, s16, -v24
  v_fma_f32 v75, v75, s16, -v24
  v_exp_f32 v72, v72
  v_exp_f32 v73, v73
  v_exp_f32 v74, v74
  v_exp_f32 v75, v75
  s_nop 0
  v_cvt_pk_bf16_f32 v64, v64, v65
  v_cvt_pk_bf16_f32 v65, v66, v67
  v_cvt_pk_bf16_f32 v66, v72, v73
  v_cvt_pk_bf16_f32 v67, v74, v75
  v_fma_f32 v68, v68, s16, -v25
  v_fma_f32 v69, v69, s16, -v25
  v_fma_f32 v70, v70, s16, -v25
  v_fma_f32 v71, v71, s16, -v25
  v_exp_f32 v68, v68
  v_exp_f32 v69, v69
  v_exp_f32 v70, v70
  v_exp_f32 v71, v71
  v_fma_f32 v76, v76, s16, -v25
  v_fma_f32 v77, v77, s16, -v25
  v_fma_f32 v78, v78, s16, -v25
  v_fma_f32 v79, v79, s16, -v25
  v_exp_f32 v76, v76
  v_exp_f32 v77, v77
  v_exp_f32 v78, v78
  v_exp_f32 v79, v79
  s_nop 0
  v_cvt_pk_bf16_f32 v68, v68, v69
  v_cvt_pk_bf16_f32 v69, v70, v71
  v_cvt_pk_bf16_f32 v70, v76, v77
  v_cvt_pk_bf16_f32 v71, v78, v79
  s_cmp_le_u32 s1, 2
  s_cbranch_scc1 L_skip_2
  v_fma_f32 v80, v80, s16, -v24
  v_fma_f32 v81, v81, s16, -v24
  v_fma_f32 v82, v82, s16, -v24
  v_fma_f32 v83, v83, s16, -v24
  v_exp_f32 v80, v80
  v_exp_f32 v81, v81
  v_exp_f32 v82, v82
  v_exp_f32 v83, v83
  v_fma_f32 v88, v88, s16, -v24
  v_fma_f32 v89, v89, s16, -v24
  v_fma_f32 v90, v90, s16, -v24
  v_fma_f32 v91, v91, s16, -v24
  v_exp_f32 v88, v88
  v_exp_f32 v89, v89
  v_exp_f32 v90, v90
  v_exp_f32 v91, v91
  s_nop 0
  v_cvt_pk_bf16_f32 v80, v80, v81
  v_cvt_pk_bf16_f32 v81, v82, v83
  v_cvt_pk_bf16_f32 v82, v88, v89
  v_cvt_pk_bf16_f32 v83, v90, v91
  v_fma_f32 v84, v84, s16, -v25
  v_fma_f32 v85, v85, s16, -v25
  v_fma_f32 v86, v86, s16, -v25
  v_fma_f32 v87, v87, s16, -v25
  v_exp_f32 v84, v84
  v_exp_f32 v85, v85
  v_exp_f32 v86, v86
  v_exp_f32 v87, v87
  v_fma_f32 v92, v92, s16, -v25
  v_fma_f32 v93, v93, s16, -v25
  v_fma_f32 v94, v94, s16, -v25
  v_fma_f32 v95, v95, s16, -v25
  v_exp_f32 v92, v92
  v_exp_f32 v93, v93
  v_exp_f32 v94, v94
  v_exp_f32 v95, v95
  s_nop 0
  v_cvt_pk_bf16_f32 v84, v84, v85
  v_cvt_pk_bf16_f32 v85, v86, v87
  v_cvt_pk_bf16_f32 v86, v92, v93
  v_cvt_pk_bf16_f32 v87, v94, v95
L_skip_2:
  s_cmp_ge_u32 s91, 0x10000
  s_cselect_b32 s38, 37748736, 0
  buffer_load_dwordx4 v[208:211], v12, s[36:39], s83 offen offset:0 nt
  buffer_load_dwordx4 v[212:215], v12, s[36:39], s83 offen offset:2048 nt
  buffer_load_dwordx4 v[216:219], v13, s[36:39], s83 offen offset:0 nt
  buffer_load_dwordx4 v[220:223], v13, s[36:39], s83 offen offset:2048 nt
  s_waitcnt vmcnt(16)
  v_perm_b32 v32, v132, v128, s17
  v_perm_b32 v33, v140, v136, s17
  v_perm_b32 v34, v148, v144, s17
  v_perm_b32 v35, v156, v152, s17
  v_perm_b32 v36, v132, v128, s18
  v_perm_b32 v37, v140, v136, s18
  v_perm_b32 v38, v148, v144, s18
  v_perm_b32 v39, v156, v152, s18
  v_mfma_f32_16x16x32_bf16 a[0:3], v[32:35], v[64:67], a[0:3]
  v_mfma_f32_16x16x32_bf16 a[32:35], v[32:35], v[68:71], a[32:35]
  v_perm_b32 v40, v133, v129, s17
  v_perm_b32 v41, v141, v137, s17
  v_perm_b32 v42, v149, v145, s17
  v_perm_b32 v43, v157, v153, s17
  v_mfma_f32_16x16x32_bf16 a[4:7], v[36:39], v[64:67], a[4:7]
  v_mfma_f32_16x16x32_bf16 a[36:39], v[36:39], v[68:71], a[36:39]
  v_perm_b32 v44, v133, v129, s18
  v_perm_b32 v45, v141, v137, s18
  v_perm_b32 v46, v149, v145, s18
  v_perm_b32 v47, v157, v153, s18
  v_mfma_f32_16x16x32_bf16 a[8:11], v[40:43], v[64:67], a[8:11]
  v_mfma_f32_16x16x32_bf16 a[40:43], v[40:43], v[68:71], a[40:43]
  v_perm_b32 v48, v134, v130, s17
  v_perm_b32 v49, v142, v138, s17
  v_perm_b32 v50, v150, v146, s17
  v_perm_b32 v51, v158, v154, s17
  v_mfma_f32_16x16x32_bf16 a[12:15], v[44:47], v[64:67], a[12:15]
  v_mfma_f32_16x16x32_bf16 a[44:47], v[44:47], v[68:71], a[44:47]
  v_perm_b32 v52, v134, v130, s18
  v_perm_b32 v53, v142, v138, s18
  v_perm_b32 v54, v150, v146, s18
  v_perm_b32 v55, v158, v154, s18
  v_mfma_f32_16x16x32_bf16 a[16:19], v[48:51], v[64:67], a[16:19]
  v_mfma_f32_16x16x32_bf16 a[48:51], v[48:51], v[68:71], a[48:51]
  v_perm_b32 v56, v135, v131, s17
  v_perm_b32 v57, v143, v139, s17
  v_perm_b32 v58, v151, v147, s17
  v_perm_b32 v59, v159, v155, s17
  v_mfma_f32_16x16x32_bf16 a[20:23], v[52:55], v[64:67], a[20:23]
  v_mfma_f32_16x16x32_bf16 a[52:55], v[52:55], v[68:71], a[52:55]
  v_perm_b32 v60, v135, v131, s18
  v_perm_b32 v61, v143, v139, s18
  v_perm_b32 v62, v151, v147, s18
  v_perm_b32 v63, v159, v155, s18
  v_mfma_f32_16x16x32_bf16 a[24:27], v[56:59], v[64:67], a[24:27]
  v_mfma_f32_16x16x32_bf16 a[56:59], v[56:59], v[68:71], a[56:59]
  v_mfma_f32_16x16x32_bf16 a[64:67], a[136:139], v[64:67], a[64:67]
  v_mfma_f32_16x16x32_bf16 a[68:71], a[136:139], v[68:71], a[68:71]
  v_mfma_f32_16x16x32_bf16 a[28:31], v[60:63], v[64:67], a[28:31]
  v_mfma_f32_16x16x32_bf16 a[60:63], v[60:63], v[68:71], a[60:63]
  s_cmp_le_u32 s1, 4
  s_cbranch_scc1 L_skip_3
  v_fma_f32 v96, v96, s16, -v24
  v_fma_f32 v97, v97, s16, -v24
  v_fma_f32 v98, v98, s16, -v24
  v_fma_f32 v99, v99, s16, -v24
  v_exp_f32 v96, v96
  v_exp_f32 v97, v97
  v_exp_f32 v98, v98
  v_exp_f32 v99, v99
  v_fma_f32 v104, v104, s16, -v24
  v_fma_f32 v105, v105, s16, -v24
  v_fma_f32 v106, v106, s16, -v24
  v_fma_f32 v107, v107, s16, -v24
  v_exp_f32 v104, v104
  v_exp_f32 v105, v105
  v_exp_f32 v106, v106
  v_exp_f32 v107, v107
  s_nop 0
  v_cvt_pk_bf16_f32 v96, v96, v97
  v_cvt_pk_bf16_f32 v97, v98, v99
  v_cvt_pk_bf16_f32 v98, v104, v105
  v_cvt_pk_bf16_f32 v99, v106, v107
  v_fma_f32 v100, v100, s16, -v25
  v_fma_f32 v101, v101, s16, -v25
  v_fma_f32 v102, v102, s16, -v25
  v_fma_f32 v103, v103, s16, -v25
  v_exp_f32 v100, v100
  v_exp_f32 v101, v101
  v_exp_f32 v102, v102
  v_exp_f32 v103, v103
  v_fma_f32 v108, v108, s16, -v25
  v_fma_f32 v109, v109, s16, -v25
  v_fma_f32 v110, v110, s16, -v25
  v_fma_f32 v111, v111, s16, -v25
  v_exp_f32 v108, v108
  v_exp_f32 v109, v109
  v_exp_f32 v110, v110
  v_exp_f32 v111, v111
  s_nop 0
  v_cvt_pk_bf16_f32 v100, v100, v101
  v_cvt_pk_bf16_f32 v101, v102, v103
  v_cvt_pk_bf16_f32 v102, v108, v109
  v_cvt_pk_bf16_f32 v103, v110, v111
L_skip_3:
  s_cmp_ge_u32 s92, 0x10000
  s_cselect_b32 s38, 37748736, 0
  buffer_load_dwordx4 v[224:227], v12, s[36:39], s84 offen offset:0 nt
  buffer_load_dwordx4 v[228:231], v12, s[36:39], s84 offen offset:2048 nt
  buffer_load_dwordx4 v[232:235], v13, s[36:39], s84 offen offset:0 nt
  buffer_load_dwordx4 v[236:239], v13, s[36:39], s84 offen offset:2048 nt
  s_cmp_le_u32 s1, 6
  s_cbranch_scc1 L_skip_4
  v_fma_f32 v112, v112, s16, -v24
  v_fma_f32 v113, v113, s16, -v24
  v_fma_f32 v114, v114, s16, -v24
  v_fma_f32 v115, v115, s16, -v24
  v_exp_f32 v112, v112
  v_exp_f32 v113, v113
  v_exp_f32 v114, v114
  v_exp_f32 v115, v115
  v_fma_f32 v120, v120, s16, -v24
  v_fma_f32 v121, v121, s16, -v24
  v_fma_f32 v122, v122, s16, -v24
  v_fma_f32 v123, v123, s16, -v24
  v_exp_f32 v120, v120
  v_exp_f32 v121, v121
  v_exp_f32 v122, v122
  v_exp_f32 v123, v123
  s_nop 0
  v_cvt_pk_bf16_f32 v112, v112, v113
  v_cvt_pk_bf16_f32 v113, v114, v115
  v_cvt_pk_bf16_f32 v114, v120, v121
  v_cvt_pk_bf16_f32 v115, v122, v123
  v_fma_f32 v116, v116, s16, -v25
  v_fma_f32 v117, v117, s16, -v25
  v_fma_f32 v118, v118, s16, -v25
  v_fma_f32 v119, v119, s16, -v25
  v_exp_f32 v116, v116
  v_exp_f32 v117, v117
  v_exp_f32 v118, v118
  v_exp_f32 v119, v119
  v_fma_f32 v124, v124, s16, -v25
  v_fma_f32 v125, v125, s16, -v25
  v_fma_f32 v126, v126, s16, -v25
  v_fma_f32 v127, v127, s16, -v25
  v_exp_f32 v124, v124
  v_exp_f32 v125, v125
  v_exp_f32 v126, v126
  v_exp_f32 v127, v127
  s_nop 0
  v_cvt_pk_bf16_f32 v116, v116, v117
  v_cvt_pk_bf16_f32 v117, v118, v119
  v_cvt_pk_bf16_f32 v118, v124, v125
  v_cvt_pk_bf16_f32 v119, v126, v127
L_skip_4:
  s_cmp_le_u32 s1, 2
  s_cbranch_scc1 L_skip_5
  s_waitcnt vmcnt(12)
  v_perm_b32 v32, v164, v160, s17
  v_perm_b32 v33, v172, v168, s17
  v_perm_b32 v34, v180, v176, s17
  v_perm_b32 v35, v188, v184, s17
  v_perm_b32 v36, v164, v160, s18
  v_perm_b32 v37, v172, v168, s18
  v_perm_b32 v38, v180, v176, s18
  v_perm_b32 v39, v188, v184, s18
  v_mfma_f32_16x16x32_bf16 a[0:3], v[32:35], v[80:83], a[0:3]
  v_mfma_f32_16x16x32_bf16 a[32:35], v[32:35], v[84:87], a[32:35]
  v_perm_b32 v40, v165, v161, s17
  v_perm_b32 v41, v173, v169, s17
  v_perm_b32 v42, v181, v177, s17
  v_perm_b32 v43, v189, v185, s17
  v_mfma_f32_16x16x32_bf16 a[4:7], v[36:39], v[80:83], a[4:7]
  v_mfma_f32_16x16x32_bf16 a[36:39], v[36:39], v[84:87], a[36:39]
  v_perm_b32 v44, v165, v161, s18
  v_perm_b32 v45, v173, v169, s18
  v_perm_b32 v46, v181, v177, s18
  v_perm_b32 v47, v189, v185, s18
  v_mfma_f32_16x16x32_bf16 a[8:11], v[40:43], v[80:83], a[8:11]
  v_mfma_f32_16x16x32_bf16 a[40:43], v[40:43], v[84:87], a[40:43]
  v_perm_b32 v48, v166, v162, s17
  v_perm_b32 v49, v174, v170, s17
  v_perm_b32 v50, v182, v178, s17
  v_perm_b32 v51, v190, v186, s17
  v_mfma_f32_16x16x32_bf16 a[12:15], v[44:47], v[80:83], a[12:15]
  v_mfma_f32_16x16x32_bf16 a[44:47], v[44:47], v[84:87], a[44:47]
  v_perm_b32 v52, v166, v162, s18
  v_perm_b32 v53, v174, v170, s18
  v_perm_b32 v54, v182, v178, s18
  v_perm_b32 v55, v190, v186, s18
  v_mfma_f32_16x16x32_bf16 a[16:19], v[48:51], v[80:83], a[16:19]
  v_mfma_f32_16x16x32_bf16 a[48:51], v[48:51], v[84:87], a[48:51]
  v_perm_b32 v56, v167, v163, s17
  v_perm_b32 v57, v175, v171, s17
  v_perm_b32 v58, v183, v179, s17
  v_perm_b32 v59, v191, v187, s17
  v_mfma_f32_16x16x32_bf16 a[20:23], v[52:55], v[80:83], a[20:23]
  v_mfma_f32_16x16x32_bf16 a[52:55], v[52:55], v[84:87], a[52:55]
  v_perm_b32 v60, v167, v163, s18
  v_perm_b32 v61, v175, v171, s18
  v_perm_b32 v62, v183, v179, s18
  v_perm_b32 v63, v191, v187, s18
  v_mfma_f32_16x16x32_bf16 a[24:27], v[56:59], v[80:83], a[24:27]
  v_mfma_f32_16x16x32_bf16 a[56:59], v[56:59], v[84:87], a[56:59]
  v_mfma_f32_16x16x32_bf16 a[64:67], a[136:139], v[80:83], a[64:67]
  v_mfma_f32_16x16x32_bf16 a[68:71], a[136:139], v[84:87], a[68:71]
  v_mfma_f32_16x16x32_bf16 a[28:31], v[60:63], v[80:83], a[28:31]
  v_mfma_f32_16x16x32_bf16 a[60:63], v[60:63], v[84:87], a[60:63]
L_skip_5:
  s_cmp_ge_u32 s93, 0x10000
  s_cselect_b32 s38, 37748736, 0
  buffer_load_dwordx4 v[240:243], v12, s[36:39], s85 offen offset:0 nt
  buffer_load_dwordx4 v[244:247], v12, s[36:39], s85 offen offset:2048 nt
  buffer_load_dwordx4 v[248:251], v13, s[36:39], s85 offen offset:0 nt
  buffer_load_dwordx4 v[252:255], v13, s[36:39], s85 offen offset:2048 nt
  s_cmp_le_u32 s1, 4
  s_cbranch_scc1 L_skip_6
  s_waitcnt vmcnt(8)
  v_perm_b32 v32, v196, v192, s17
  v_perm_b32 v33, v204, v200, s17
  v_perm_b32 v34, v212, v208, s17
  v_perm_b32 v35, v220, v216, s17
  v_perm_b32 v36, v196, v192, s18
  v_perm_b32 v37, v204, v200, s18
  v_perm_b32 v38, v212, v208, s18
  v_perm_b32 v39, v220, v216, s18
  v_mfma_f32_16x16x32_bf16 a[0:3], v[32:35], v[96:99], a[0:3]
  v_mfma_f32_16x16x32_bf16 a[32:35], v[32:35], v[100:103], a[32:35]
  v_perm_b32 v40, v197, v193, s17
  v_perm_b32 v41, v205, v201, s17
  v_perm_b32 v42, v213, v209, s17
  v_perm_b32 v43, v221, v217, s17
  v_mfma_f32_16x16x32_bf16 a[4:7], v[36:39], v[96:99], a[4:7]
  v_mfma_f32_16x16x32_bf16 a[36:39], v[36:39], v[100:103], a[36:39]
  v_perm_b32 v44, v197, v193, s18
  v_perm_b32 v45, v205, v201, s18
  v_perm_b32 v46, v213, v209, s18
  v_perm_b32 v47, v221, v217, s18
  v_mfma_f32_16x16x32_bf16 a[8:11], v[40:43], v[96:99], a[8:11]
  v_mfma_f32_16x16x32_bf16 a[40:43], v[40:43], v[100:103], a[40:43]
  v_perm_b32 v48, v198, v194, s17
  v_perm_b32 v49, v206, v202, s17
  v_perm_b32 v50, v214, v210, s17
  v_perm_b32 v51, v222, v218, s17
  v_mfma_f32_16x16x32_bf16 a[12:15], v[44:47], v[96:99], a[12:15]
  v_mfma_f32_16x16x32_bf16 a[44:47], v[44:47], v[100:103], a[44:47]
  v_perm_b32 v52, v198, v194, s18
  v_perm_b32 v53, v206, v202, s18
  v_perm_b32 v54, v214, v210, s18
  v_perm_b32 v55, v222, v218, s18
  v_mfma_f32_16x16x32_bf16 a[16:19], v[48:51], v[96:99], a[16:19]
  v_mfma_f32_16x16x32_bf16 a[48:51], v[48:51], v[100:103], a[48:51]
  v_perm_b32 v56, v199, v195, s17
  v_perm_b32 v57, v207, v203, s17
  v_perm_b32 v58, v215, v211, s17
  v_perm_b32 v59, v223, v219, s17
  v_mfma_f32_16x16x32_bf16 a[20:23], v[52:55], v[96:99], a[20:23]
  v_mfma_f32_16x16x32_bf16 a[52:55], v[52:55], v[100:103], a[52:55]
  v_perm_b32 v60, v199, v195, s18
  v_perm_b32 v61, v207, v203, s18
  v_perm_b32 v62, v215, v211, s18
  v_perm_b32 v63, v223, v219, s18
  v_mfma_f32_16x16x32_bf16 a[24:27], v[56:59], v[96:99], a[24:27]
  v_mfma_f32_16x16x32_bf16 a[56:59], v[56:59], v[100:103], a[56:59]
  v_mfma_f32_16x16x32_bf16 a[64:67], a[136:139], v[96:99], a[64:67]
  v_mfma_f32_16x16x32_bf16 a[68:71], a[136:139], v[100:103], a[68:71]
  v_mfma_f32_16x16x32_bf16 a[28:31], v[60:63], v[96:99], a[28:31]
  v_mfma_f32_16x16x32_bf16 a[60:63], v[60:63], v[100:103], a[60:63]
L_skip_6:
  s_cmp_le_u32 s1, 6
  s_cbranch_scc1 L_skip_7
  s_waitcnt vmcnt(0)
  v_perm_b32 v32, v228, v224, s17
  v_perm_b32 v33, v236, v232, s17
  v_perm_b32 v34, v244, v240, s17
  v_perm_b32 v35, v252, v248, s17
  v_perm_b32 v36, v228, v224, s18
  v_perm_b32 v37, v236, v232, s18
  v_perm_b32 v38, v244, v240, s18
  v_perm_b32 v39, v252, v248, s18
  v_mfma_f32_16x16x32_bf16 a[0:3], v[32:35], v[112:115], a[0:3]
  v_mfma_f32_16x16x32_bf16 a[32:35], v[32:35], v[116:119], a[32:35]
  v_perm_b32 v40, v229, v225, s17
  v_perm_b32 v41, v237, v233, s17
  v_perm_b32 v42, v245, v241, s17
  v_perm_b32 v43, v253, v249, s17
  v_mfma_f32_16x16x32_bf16 a[4:7], v[36:39], v[112:115], a[4:7]
  v_mfma_f32_16x16x32_bf16 a[36:39], v[36:39], v[116:119], a[36:39]
  v_perm_b32 v44, v229, v225, s18
  v_perm_b32 v45, v237, v233, s18
  v_perm_b32 v46, v245, v241, s18
  v_perm_b32 v47, v253, v249, s18
  v_mfma_f32_16x16x32_bf16 a[8:11], v[40:43], v[112:115], a[8:11]
  v_mfma_f32_16x16x32_bf16 a[40:43], v[40:43], v[116:119], a[40:43]
  v_perm_b32 v48, v230, v226, s17
  v_perm_b32 v49, v238, v234, s17
  v_perm_b32 v50, v246, v242, s17
  v_perm_b32 v51, v254, v250, s17
  v_mfma_f32_16x16x32_bf16 a[12:15], v[44:47], v[112:115], a[12:15]
  v_mfma_f32_16x16x32_bf16 a[44:47], v[44:47], v[116:119], a[44:47]
  v_perm_b32 v52, v230, v226, s18
  v_perm_b32 v53, v238, v234, s18
  v_perm_b32 v54, v246, v242, s18
  v_perm_b32 v55, v254, v250, s18
  v_mfma_f32_16x16x32_bf16 a[16:19], v[48:51], v[112:115], a[16:19]
  v_mfma_f32_16x16x32_bf16 a[48:51], v[48:51], v[116:119], a[48:51]
  v_perm_b32 v56, v231, v227, s17
  v_perm_b32 v57, v239, v235, s17
  v_perm_b32 v58, v247, v243, s17
  v_perm_b32 v59, v255, v251, s17
  v_mfma_f32_16x16x32_bf16 a[20:23], v[52:55], v[112:115], a[20:23]
  v_mfma_f32_16x16x32_bf16 a[52:55], v[52:55], v[116:119], a[52:55]
  v_perm_b32 v60, v231, v227, s18
  v_perm_b32 v61, v239, v235, s18
  v_perm_b32 v62, v247, v243, s18
  v_perm_b32 v63, v255, v251, s18
  v_mfma_f32_16x16x32_bf16 a[24:27], v[56:59], v[112:115], a[24:27]
  v_mfma_f32_16x16x32_bf16 a[56:59], v[56:59], v[116:119], a[56:59]
  v_mfma_f32_16x16x32_bf16 a[64:67], a[136:139], v[112:115], a[64:67]
  v_mfma_f32_16x16x32_bf16 a[68:71], a[136:139], v[116:119], a[68:71]
  v_mfma_f32_16x16x32_bf16 a[28:31], v[60:63], v[112:115], a[28:31]
  v_mfma_f32_16x16x32_bf16 a[60:63], v[60:63], v[116:119], a[60:63]
L_skip_7:
  s_add_u32 s13, s13, 1
  s_cmp_lt_u32 s13, s12
  s_nop 7
  s_cbranch_scc1 L_nextround
  v_add_u32 v26, 0, v3
  v_mul_u32_u24 v26, 520, v26
  v_add_u32 v26, s77, v26
  v_lshl_add_u32 v27, v2, 7, v26
  ds_write2_b32 v27, a0, a4 offset0:0 offset1:1
  ds_write2_b32 v27, a8, a12 offset0:2 offset1:3
  ds_write2_b32 v27, a16, a20 offset0:4 offset1:5
  ds_write2_b32 v27, a24, a28 offset0:6 offset1:7
  ds_write2_b32 v27, a1, a5 offset0:8 offset1:9
  ds_write2_b32 v27, a9, a13 offset0:10 offset1:11
  ds_write2_b32 v27, a17, a21 offset0:12 offset1:13
  ds_write2_b32 v27, a25, a29 offset0:14 offset1:15
  ds_write2_b32 v27, a2, a6 offset0:16 offset1:17
  ds_write2_b32 v27, a10, a14 offset0:18 offset1:19
  ds_write2_b32 v27, a18, a22 offset0:20 offset1:21
  ds_write2_b32 v27, a26, a30 offset0:22 offset1:23
  ds_write2_b32 v27, a3, a7 offset0:24 offset1:25
  ds_write2_b32 v27, a11, a15 offset0:26 offset1:27
  ds_write2_b32 v27, a19, a23 offset0:28 offset1:29
  ds_write2_b32 v27, a27, a31 offset0:30 offset1:31
  ds_write_b32 v26, v22 offset:512
  ds_write_b32 v26, a64 offset:516
  v_add_u32 v26, 16, v3
  v_mul_u32_u24 v26, 520, v26
  v_add_u32 v26, s77, v26
  v_lshl_add_u32 v27, v2, 7, v26
  ds_write2_b32 v27, a32, a36 offset0:0 offset1:1
  ds_write2_b32 v27, a40, a44 offset0:2 offset1:3
  ds_write2_b32 v27, a48, a52 offset0:4 offset1:5
  ds_write2_b32 v27, a56, a60 offset0:6 offset1:7
  ds_write2_b32 v27, a33, a37 offset0:8 offset1:9
  ds_write2_b32 v27, a41, a45 offset0:10 offset1:11
  ds_write2_b32 v27, a49, a53 offset0:12 offset1:13
  ds_write2_b32 v27, a57, a61 offset0:14 offset1:15
  ds_write2_b32 v27, a34, a38 offset0:16 offset1:17
  ds_write2_b32 v27, a42, a46 offset0:18 offset1:19
  ds_write2_b32 v27, a50, a54 offset0:20 offset1:21
  ds_write2_b32 v27, a58, a62 offset0:22 offset1:23
  ds_write2_b32 v27, a35, a39 offset0:24 offset1:25
  ds_write2_b32 v27, a43, a47 offset0:26 offset1:27
  ds_write2_b32 v27, a51, a55 offset0:28 offset1:29
  ds_write2_b32 v27, a59, a63 offset0:30 offset1:31
  ds_write_b32 v26, v23 offset:512
  ds_write_b32 v26, a68 offset:516
  s_branch L_tail
L_drain2_2:
  s_cmp_ge_u32 s91, 0x10000
  s_cselect_b32 s34, 37748736, 0
  s_mov_b32 s23, s83
  buffer_load_dwordx4 v4, s[32:35], s23 offen nt lds
  s_add_u32 m0, m0, 0x400
  s_add_u32 s23, s23, 0x2000
  buffer_load_dwordx4 v5, s[32:35], s23 offen nt lds
  s_add_u32 m0, m0, 0x400
  s_add_u32 s23, s23, 0x2000
  buffer_load_dwordx4 v6, s[32:35], s23 offen nt lds
  s_add_u32 m0, m0, 0x400
  s_add_u32 s23, s23, 0x2000
  buffer_load_dwordx4 v7, s[32:35], s23 offen nt lds
  s_add_u32 m0, m0, 0x400
  s_cmp_ge_u32 s92, 0x10000
  s_cselect_b32 s34, 37748736, 0
  s_mov_b32 s23, s84
  buffer_load_dwordx4 v4, s[32:35], s23 offen nt lds
  s_add_u32 m0, m0, 0x400
  s_add_u32 s23, s23, 0x2000
  buffer_load_dwordx4 v5, s[32:35], s23 offen nt lds
  s_add_u32 m0, m0, 0x400
  s_add_u32 s23, s23, 0x2000
  buffer_load_dwordx4 v6, s[32:35], s23 offen nt lds
  s_add_u32 m0, m0, 0x400
  s_add_u32 s23, s23, 0x2000
  buffer_load_dwordx4 v7, s[32:35], s23 offen nt lds
  s_add_u32 m0, m0, 0x400
  s_cmp_ge_u32 s93, 0x10000
  s_cselect_b32 s34, 37748736, 0
  s_mov_b32 s23, s85
  buffer_load_dwordx4 v4, s[32:35], s23 offen nt lds
  s_add_u32 m0, m0, 0x400
  s_add_u32 s23, s23, 0x2000
  buffer_load_dwordx4 v5, s[32:35], s23 offen nt lds
  s_add_u32 m0, m0, 0x400
  s_add_u32 s23, s23, 0x2000
  buffer_load_dwordx4 v6, s[32:35], s23 offen nt lds
  s_add_u32 m0, m0, 0x400
  s_add_u32 s23, s23, 0x2000
  buffer_load_dwordx4 v7, s[32:35], s23 offen nt lds
  s_add_u32 m0, m0, 0x400
  s_cmp_ge_u32 s86, 0x10000
  s_cselect_b32 s38, 37748736, 0
  buffer_load_dwordx4 v[128:131], v12, s[36:39], s78 offen offset:0 nt
  buffer_load_dwordx4 v[132:135], v12, s[36:39], s78 offen offset:2048 nt
  buffer_load_dwordx4 v[136:139], v13, s[36:39], s78 offen offset:0 nt
  buffer_load_dwordx4 v[140:143], v13, s[36:39], s78 offen offset:2048 nt
  s_cmp_ge_u32 s87, 0x10000
  s_cselect_b32 s38, 37748736, 0
  buffer_load_dwordx4 v[144:147], v12, s[36:39], s79 offen offset:0 nt
  buffer_load_dwordx4 v[148:151], v12, s[36:39], s79 offen offset:2048 nt
  buffer_load_dwordx4 v[152:155], v13, s[36:39], s79 offen offset:0 nt
  buffer_load_dwordx4 v[156:159], v13, s[36:39], s79 offen offset:2048 nt
  s_cmp_ge_u32 s88, 0x10000
  s_cselect_b32 s38, 37748736, 0
  buffer_load_dwordx4 v[160:163], v12, s[36:39], s80 offen offset:0 nt
  buffer_load_dwordx4 v[164:167], v12, s[36:39], s80 offen offset:2048 nt
  buffer_load_dwordx4 v[168:171], v13, s[36:39], s80 offen offset:0 nt
  buffer_load_dwordx4 v[172:175], v13, s[36:39], s80 offen offset:2048 nt
  s_cmp_ge_u32 s89, 0x10000
  s_cselect_b32 s38, 37748736, 0
  buffer_load_dwordx4 v[176:179], v12, s[36:39], s81 offen offset:0 nt
  buffer_load_dwordx4 v[180:183], v12, s[36:39], s81 offen offset:2048 nt
  buffer_load_dwordx4 v[184:187], v13, s[36:39], s81 offen offset:0 nt
  buffer_load_dwordx4 v[188:191], v13, s[36:39], s81 offen offset:2048 nt
  s_nop 3
  s_and_b32 s15, s87, 0xffff
  v_and_b32 v26, s87, v16
  v_cmp_ne_u32 vcc, 0, v26
  v_subrev_u32 v27, s15, v14
  s_nop 0
  v_cndmask_b32 v27, -1, v27, vcc
  v_cmp_lt_i32_e64 s[94:95], 0, v27
  v_cmp_lt_i32_e64 s[96:97], 1, v27
  v_cmp_lt_i32_e64 s[98:99], 2, v27
  v_cmp_lt_i32_e64 s[100:101], 3, v27
  v_cndmask_b32_e64 v72, v18, v72, s[94:95]
  v_cndmask_b32_e64 v73, v18, v73, s[96:97]
  v_cndmask_b32_e64 v74, v18, v74, s[98:99]
  v_cndmask_b32_e64 v75, v18, v75, s[100:101]
  v_max3_f32 v24, v72, v73, v24
  v_max3_f32 v24, v74, v75, v24
  v_and_b32 v26, s87, v17
  v_cmp_ne_u32 vcc, 0, v26
  v_subrev_u32 v27, s15, v15
  s_nop 0
  v_cndmask_b32 v27, -1, v27, vcc
  v_cmp_lt_i32_e64 s[94:95], 0, v27
  v_cmp_lt_i32_e64 s[96:97], 1, v27
  v_cmp_lt_i32_e64 s[98:99], 2, v27
  v_cmp_lt_i32_e64 s[100:101], 3, v27
  v_cndmask_b32_e64 v76, v18, v76, s[94:95]
  v_cndmask_b32_e64 v77, v18, v77, s[96:97]
  v_cndmask_b32_e64 v78, v18, v78, s[98:99]
  v_cndmask_b32_e64 v79, v18, v79, s[100:101]
  v_max3_f32 v25, v76, v77, v25
  v_max3_f32 v25, v78, v79, v25
  s_branch L_join_2
L_drain4_2:
  s_cmp_ge_u32 s93, 0x10000
  s_cselect_b32 s34, 37748736, 0
  s_mov_b32 s23, s85
  buffer_load_dwordx4 v4, s[32:35], s23 offen nt lds
  s_add_u32 m0, m0, 0x400
  s_add_u32 s23, s23, 0x2000
  buffer_load_dwordx4 v5, s[32:35], s23 offen nt lds
  s_add_u32 m0, m0, 0x400
  s_add_u32 s23, s23, 0x2000
  buffer_load_dwordx4 v6, s[32:35], s23 offen nt lds
  s_add_u32 m0, m0, 0x400
  s_add_u32 s23, s23, 0x2000
  buffer_load_dwordx4 v7, s[32:35], s23 offen nt lds
  s_add_u32 m0, m0, 0x400
  s_cmp_ge_u32 s86, 0x10000
  s_cselect_b32 s38, 37748736, 0
  buffer_load_dwordx4 v[128:131], v12, s[36:39], s78 offen offset:0 nt
  buffer_load_dwordx4 v[132:135], v12, s[36:39], s78 offen offset:2048 nt
  buffer_load_dwordx4 v[136:139], v13, s[36:39], s78 offen offset:0 nt
  buffer_load_dwordx4 v[140:143], v13, s[36:39], s78 offen offset:2048 nt
  s_cmp_ge_u32 s87, 0x10000
  s_cselect_b32 s38, 37748736, 0
  buffer_load_dwordx4 v[144:147], v12, s[36:39], s79 offen offset:0 nt
  buffer_load_dwordx4 v[148:151], v12, s[36:39], s79 offen offset:2048 nt
  buffer_load_dwordx4 v[152:155], v13, s[36:39], s79 offen offset:0 nt
  buffer_load_dwordx4 v[156:159], v13, s[36:39], s79 offen offset:2048 nt
  s_cmp_ge_u32 s88, 0x10000
  s_cselect_b32 s38, 37748736, 0
  buffer_load_dwordx4 v[160:163], v12, s[36:39], s80 offen offset:0 nt
  buffer_load_dwordx4 v[164:167], v12, s[36:39], s80 offen offset:2048 nt
  buffer_load_dwordx4 v[168:171], v13, s[36:39], s80 offen offset:0 nt
  buffer_load_dwordx4 v[172:175], v13, s[36:39], s80 offen offset:2048 nt
  s_cmp_ge_u32 s89, 0x10000
  s_cselect_b32 s38, 37748736, 0
  buffer_load_dwordx4 v[176:179], v12, s[36:39], s81 offen offset:0 nt
  buffer_load_dwordx4 v[180:183], v12, s[36:39], s81 offen offset:2048 nt
  buffer_load_dwordx4 v[184:187], v13, s[36:39], s81 offen offset:0 nt
  buffer_load_dwordx4 v[188:191], v13, s[36:39], s81 offen offset:2048 nt
  s_nop 3
  s_and_b32 s15, s89, 0xffff
  v_and_b32 v26, s89, v16
  v_cmp_ne_u32 vcc, 0, v26
  v_subrev_u32 v27, s15, v14
  s_nop 0
  v_cndmask_b32 v27, -1, v27, vcc
  v_cmp_lt_i32_e64 s[94:95], 0, v27
  v_cmp_lt_i32_e64 s[96:97], 1, v27
  v_cmp_lt_i32_e64 s[98:99], 2, v27
  v_cmp_lt_i32_e64 s[100:101], 3, v27
  v_cndmask_b32_e64 v88, v18, v88, s[94:95]
  v_cndmask_b32_e64 v89, v18, v89, s[96:97]
  v_cndmask_b32_e64 v90, v18, v90, s[98:99]
  v_cndmask_b32_e64 v91, v18, v91, s[100:101]
  v_max3_f32 v24, v88, v89, v24
  v_max3_f32 v24, v90, v91, v24
  v_and_b32 v26, s89, v17
  v_cmp_ne_u32 vcc, 0, v26
  v_subrev_u32 v27, s15, v15
  s_nop 0
  v_cndmask_b32 v27, -1, v27, vcc
  v_cmp_lt_i32_e64 s[94:95], 0, v27
  v_cmp_lt_i32_e64 s[96:97], 1, v27
  v_cmp_lt_i32_e64 s[98:99], 2, v27
  v_cmp_lt_i32_e64 s[100:101], 3, v27
  v_cndmask_b32_e64 v92, v18, v92, s[94:95]
  v_cndmask_b32_e64 v93, v18, v93, s[96:97]
  v_cndmask_b32_e64 v94, v18, v94, s[98:99]
  v_cndmask_b32_e64 v95, v18, v95, s[100:101]
  v_max3_f32 v25, v92, v93, v25
  v_max3_f32 v25, v94, v95, v25
  s_branch L_join_2
L_drain6_2:
  s_cmp_ge_u32 s87, 0x10000
  s_cselect_b32 s38, 37748736, 0
  buffer_load_dwordx4 v[144:147], v12, s[36:39], s79 offen offset:0 nt
  buffer_load_dwordx4 v[148:151], v12, s[36:39], s79 offen offset:2048 nt
  buffer_load_dwordx4 v[152:155], v13, s[36:39], s79 offen offset:0 nt
  buffer_load_dwordx4 v[156:159], v13, s[36:39], s79 offen offset:2048 nt
  s_cmp_ge_u32 s88, 0x10000
  s_cselect_b32 s38, 37748736, 0
  buffer_load_dwordx4 v[160:163], v12, s[36:39], s80 offen offset:0 nt
  buffer_load_dwordx4 v[164:167], v12, s[36:39], s80 offen offset:2048 nt
  buffer_load_dwordx4 v[168:171], v13, s[36:39], s80 offen offset:0 nt
  buffer_load_dwordx4 v[172:175], v13, s[36:39], s80 offen offset:2048 nt
  s_cmp_ge_u32 s89, 0x10000
  s_cselect_b32 s38, 37748736, 0
  buffer_load_dwordx4 v[176:179], v12, s[36:39], s81 offen offset:0 nt
  buffer_load_dwordx4 v[180:183], v12, s[36:39], s81 offen offset:2048 nt
  buffer_load_dwordx4 v[184:187], v13, s[36:39], s81 offen offset:0 nt
  buffer_load_dwordx4 v[188:191], v13, s[36:39], s81 offen offset:2048 nt
  s_nop 3
  s_and_b32 s15, s91, 0xffff
  v_and_b32 v26, s91, v16
  v_cmp_ne_u32 vcc, 0, v26
  v_subrev_u32 v27, s15, v14
  s_nop 0
  v_cndmask_b32 v27, -1, v27, vcc
  v_cmp_lt_i32_e64 s[94:95], 0, v27
  v_cmp_lt_i32_e64 s[96:97], 1, v27
  v_cmp_lt_i32_e64 s[98:99], 2, v27
  v_cmp_lt_i32_e64 s[100:101], 3, v27
  v_cndmask_b32_e64 v104, v18, v104, s[94:95]
  v_cndmask_b32_e64 v105, v18, v105, s[96:97]
  v_cndmask_b32_e64 v106, v18, v106, s[98:99]
  v_cndmask_b32_e64 v107, v18, v107, s[100:101]
  v_max3_f32 v24, v104, v105, v24
  v_max3_f32 v24, v106, v107, v24
  v_and_b32 v26, s91, v17
  v_cmp_ne_u32 vcc, 0, v26
  v_subrev_u32 v27, s15, v15
  s_nop 0
  v_cndmask_b32 v27, -1, v27, vcc
  v_cmp_lt_i32_e64 s[94:95], 0, v27
  v_cmp_lt_i32_e64 s[96:97], 1, v27
  v_cmp_lt_i32_e64 s[98:99], 2, v27
  v_cmp_lt_i32_e64 s[100:101], 3, v27
  v_cndmask_b32_e64 v108, v18, v108, s[94:95]
  v_cndmask_b32_e64 v109, v18, v109, s[96:97]
  v_cndmask_b32_e64 v110, v18, v110, s[98:99]
  v_cndmask_b32_e64 v111, v18, v111, s[100:101]
  v_max3_f32 v25, v108, v109, v25
  v_max3_f32 v25, v110, v111, v25
  s_branch L_join_2
L_nextround:
  v_add_u32 v26, 8, v1
  v_lshlrev_b32 v26, 2, v26
  ds_bpermute_b32 v19, v26, v19
  ds_bpermute_b32 v20, v26, v20
  s_waitcnt lgkmcnt(0)
L_restart:
  s_waitcnt vmcnt(0)
  s_mov_b32 m0, s77
  v_readlane_b32 s78, v19, 0
  v_readlane_b32 s86, v20, 0
  v_readlane_b32 s79, v19, 1
  v_readlane_b32 s87, v20, 1
  v_readlane_b32 s80, v19, 2
  v_readlane_b32 s88, v20, 2
  v_readlane_b32 s81, v19, 3
  v_readlane_b32 s89, v20, 3
  v_readlane_b32 s82, v19, 4
  v_readlane_b32 s90, v20, 4
  v_readlane_b32 s83, v19, 5
  v_readlane_b32 s91, v20, 5
  v_readlane_b32 s84, v19, 6
  v_readlane_b32 s92, v20, 6
  v_readlane_b32 s85, v19, 7
  v_readlane_b32 s93, v20, 7
  s_nop 0
  s_cmp_ge_u32 s86, 0x10000
  s_cselect_b32 s34, 37748736, 0
  s_mov_b32 s23, s78
  buffer_load_dwordx4 v4, s[32:35], s23 offen nt lds
  s_add_u32 m0, m0, 0x400
  s_add_u32 s23, s23, 0x2000
  buffer_load_dwordx4 v5, s[32:35], s23 offen nt lds
  s_add_u32 m0, m0, 0x400
  s_add_u32 s23, s23, 0x2000
  buffer_load_dwordx4 v6, s[32:35], s23 offen nt lds
  s_add_u32 m0, m0, 0x400
  s_add_u32 s23, s23, 0x2000
  buffer_load_dwordx4 v7, s[32:35], s23 offen nt lds
  s_add_u32 m0, m0, 0x400
  s_cmp_ge_u32 s87, 0x10000
  s_cselect_b32 s34, 37748736, 0
  s_mov_b32 s23, s79
  buffer_load_dwordx4 v4, s[32:35], s23 offen nt lds
  s_add_u32 m0, m0, 0x400
  s_add_u32 s23, s23, 0x2000
  buffer_load_dwordx4 v5, s[32:35], s23 offen nt lds
  s_add_u32 m0, m0, 0x400
  s_add_u32 s23, s23, 0x2000
  buffer_load_dwordx4 v6, s[32:35], s23 offen nt lds
  s_add_u32 m0, m0, 0x400
  s_add_u32 s23, s23, 0x2000
  buffer_load_dwordx4 v7, s[32:35], s23 offen nt lds
  s_add_u32 m0, m0, 0x400
  s_cmp_ge_u32 s88, 0x10000
  s_cselect_b32 s34, 37748736, 0
  s_mov_b32 s23, s80
  buffer_load_dwordx4 v4, s[32:35], s23 offen nt lds
  s_add_u32 m0, m0, 0x400
  s_add_u32 s23, s23, 0x2000
  buffer_load_dwordx4 v5, s[32:35], s23 offen nt lds
  s_add_u32 m0, m0, 0x400
  s_add_u32 s23, s23, 0x2000
  buffer_load_dwordx4 v6, s[32:35], s23 offen nt lds
  s_add_u32 m0, m0, 0x400
  s_add_u32 s23, s23, 0x2000
  buffer_load_dwordx4 v7, s[32:35], s23 offen nt lds
  s_add_u32 m0, m0, 0x400
  s_mov_b32 s15, 0x10000
  v_cmp_le_u32 vcc, s15, v20
  s_nop 1
  s_and_b32 s1, vcc_lo, 0xff
  s_bcnt1_i32_b32 s1, s1
  s_waitcnt vmcnt(0)
  s_branch L_setup_done
L_fix:
  s_lshl_b32 s15, s4, 8
  v_lshlrev_b32 v19, 15, v62
  v_add_u32 v19, s15, v19
  s_cmp_lt_u32 s5, 6
  s_cbranch_scc0 L_restart
  v_and_b32 v26, 7, v1
  v_lshlrev_b32 v26, 2, v26
  ds_bpermute_b32 v27, v26, v62
  s_mov_b32 s15, 0x10000
  v_cmp_le_u32_e64 s[94:95], s15, v20
  s_waitcnt lgkmcnt(0)
  v_cmp_ne_u32 vcc, v62, v27
  s_nop 1
  s_and_b64 vcc, vcc, s[94:95]
  s_cbranch_vccz L_restart
  s_mov_b32 s12, 8
  v_lshrrev_b32 v26, 3, v1
  v_add_u32 v26, 16, v26
  v_lshlrev_b32_e64 v26, v26, 1
  v_and_b32 v27, 0xffff, v20
  v_or_b32 v26, v26, v27
  v_cndmask_b32_e64 v20, v20, v26, s[94:95]
  s_nop 0
  s_branch L_restart
L_setupB:
  s_mov_b32 s17, 0x05040100
  s_mov_b32 s18, 0x07060302
  v_accvgpr_write_b32 a0, 0
  v_accvgpr_write_b32 a1, 0
  v_accvgpr_write_b32 a2, 0
  v_accvgpr_write_b32 a3, 0
  v_accvgpr_write_b32 a4, 0
  v_accvgpr_write_b32 a5, 0
  v_accvgpr_write_b32 a6, 0
  v_accvgpr_write_b32 a7, 0
  v_accvgpr_write_b32 a8, 0
  v_accvgpr_write_b32 a9, 0
  v_accvgpr_write_b32 a10, 0
  v_accvgpr_write_b32 a11, 0
  v_accvgpr_write_b32 a12, 0
  v_accvgpr_write_b32 a13, 0
  v_accvgpr_write_b32 a14, 0
  v_accvgpr_write_b32 a15, 0
  v_accvgpr_write_b32 a16, 0
  v_accvgpr_write_b32 a17, 0
  v_accvgpr_write_b32 a18, 0
  v_accvgpr_write_b32 a19, 0
  v_accvgpr_write_b32 a20, 0
  v_accvgpr_write_b32 a21, 0
  v_accvgpr_write_b32 a22, 0
  v_accvgpr_write_b32 a23, 0
  v_accvgpr_write_b32 a24, 0
  v_accvgpr_write_b32 a25, 0
  v_accvgpr_write_b32 a26, 0
  v_accvgpr_write_b32 a27, 0
  v_accvgpr_write_b32 a28, 0
  v_accvgpr_write_b32 a29, 0
  v_accvgpr_write_b32 a30, 0
  v_accvgpr_write_b32 a31, 0
  v_accvgpr_write_b32 a32, 0
  v_accvgpr_write_b32 a33, 0
  v_accvgpr_write_b32 a34, 0
  v_accvgpr_write_b32 a35, 0
  v_accvgpr_write_b32 a36, 0
  v_accvgpr_write_b32 a37, 0
  v_accvgpr_write_b32 a38, 0
  v_accvgpr_write_b32 a39, 0
  v_accvgpr_write_b32 a40, 0
  v_accvgpr_write_b32 a41, 0
  v_accvgpr_write_b32 a42, 0
  v_accvgpr_write_b32 a43, 0
  v_accvgpr_write_b32 a44, 0
  v_accvgpr_write_b32 a45, 0
  v_accvgpr_write_b32 a46, 0
  v_accvgpr_write_b32 a47, 0
  v_accvgpr_write_b32 a48, 0
  v_accvgpr_write_b32 a49, 0
  v_accvgpr_write_b32 a50, 0
  v_accvgpr_write_b32 a51, 0
  v_accvgpr_write_b32 a52, 0
  v_accvgpr_write_b32 a53, 0
  v_accvgpr_write_b32 a54, 0
  v_accvgpr_write_b32 a55, 0
  v_accvgpr_write_b32 a56, 0
  v_accvgpr_write_b32 a57, 0
  v_accvgpr_write_b32 a58, 0
  v_accvgpr_write_b32 a59, 0
  v_accvgpr_write_b32 a60, 0
  v_accvgpr_write_b32 a61, 0
  v_accvgpr_write_b32 a62, 0
  v_accvgpr_write_b32 a63, 0
  v_accvgpr_write_b32 a64, 0
  v_accvgpr_write_b32 a65, 0
  v_accvgpr_write_b32 a66, 0
  v_accvgpr_write_b32 a67, 0
  v_accvgpr_write_b32 a68, 0
  v_accvgpr_write_b32 a69, 0
  v_accvgpr_write_b32 a70, 0
  v_accvgpr_write_b32 a71, 0
  v_mov_b32 v26, 0x3f803f80
  v_accvgpr_write_b32 a136, v26
  v_accvgpr_write_b32 a137, v26
  v_accvgpr_write_b32 a138, v26
  v_accvgpr_write_b32 a139, v26
  v_mov_b32 v22, 0xff7fffff
  v_mov_b32 v23, 0xff7fffff
  s_cmp_lg_u32 s0, 0
  s_cbranch_scc1 L_havecum
  s_mov_b32 s68, 0
  s_mov_b32 s15, -3057
  s_min_i32 s60, s60, 4096
  s_add_i32 s14, s60, s15
  s_max_i32 s14, s14, 0
  s_lshr_b32 s14, s14, 4
  s_add_u32 s69, s68, s14
  s_min_i32 s61, s61, 4096
  s_add_i32 s14, s61, s15
  s_max_i32 s14, s14, 0
  s_lshr_b32 s14, s14, 4
  s_add_u32 s70, s69, s14
  s_min_i32 s62, s62, 4096
  s_add_i32 s14, s62, s15
  s_max_i32 s14, s14, 0
  s_lshr_b32 s14, s14, 4
  s_add_u32 s71, s70, s14
  s_min_i32 s63, s63, 4096
  s_add_i32 s14, s63, s15
  s_max_i32 s14, s14, 0
  s_lshr_b32 s14, s14, 4
  s_add_u32 s72, s71, s14
  s_min_i32 s64, s64, 4096
  s_add_i32 s14, s64, s15
  s_max_i32 s14, s14, 0
  s_lshr_b32 s14, s14, 4
  s_add_u32 s73, s72, s14
  s_min_i32 s65, s65, 4096
  s_add_i32 s14, s65, s15
  s_max_i32 s14, s14, 0
  s_lshr_b32 s14, s14, 4
  s_add_u32 s74, s73, s14
  s_min_i32 s66, s66, 4096
  s_add_i32 s14, s66, s15
  s_max_i32 s14, s14, 0
  s_lshr_b32 s14, s14, 4
  s_add_u32 s75, s74, s14
  s_min_i32 s67, s67, 4096
  s_add_i32 s14, s67, s15
  s_max_i32 s14, s14, 0
  s_lshr_b32 s14, s14, 4
  s_add_u32 s76, s75, s14
  s_mov_b32 s15, 9
  s_add_u32 s14, s76, s15
  s_mov_b32 s15, 6554
  s_mul_i32 s14, s14, s15
  s_lshr_b32 s14, s14, 16
L_havecum:
  v_mov_b32 v26, 139264
  v_mov_b32 v27, 0
  v_lshl_add_u32 v26, v3, 2, v26
  ds_write_b32 v26, v27
  v_writelane_b32 v21, s68, 0
  v_writelane_b32 v21, s69, 1
  v_writelane_b32 v21, s70, 2
  v_writelane_b32 v21, s71, 3
  v_writelane_b32 v21, s72, 4
  v_writelane_b32 v21, s73, 5
  v_writelane_b32 v21, s74, 6
  v_writelane_b32 v21, s75, 7
  v_writelane_b32 v21, s76, 8
  s_mov_b32 s24, s76
  s_lshl_b32 s15, s3, 1
  s_lshl_b32 s19, s7, 2
  s_add_u32 s19, s19, s3
  s_cmp_lg_u32 s6, 0
  s_cselect_b32 s26, s15, s19
  s_sub_u32 s15, s5, 6
  s_lshr_b32 s19, s15, 1
  s_cmp_lt_u32 s15, 16
  s_cselect_b32 s26, s19, s26
  s_add_u32 s27, s26, 1
  v_mul_u32_u24 v26, s14, v1
  v_add_u32 v27, s14, v26
  v_min_u32 v26, s24, v26
  v_min_u32 v27, s24, v27
  s_min_u32 s21, s26, 7
  s_add_u32 s15, s21, 1
  v_readlane_b32 s19, v21, s21
  v_readlane_b32 s20, v21, s15
  s_mov_b32 s21, 1023
  s_nop 0
  v_cmp_gt_u32 vcc, s20, v26
  v_cmp_lt_u32_e64 s[94:95], s19, v27
  s_nop 1
  s_and_b32 s30, vcc_lo, s94
  s_and_b32 s30, s30, s21
  s_lshl_b32 s30, s30, 8
  s_or_b32 s30, s30, 255
  s_lshr_b32 s15, s30, s50
  s_and_b32 s15, s15, 1
  s_cmp_lg_u32 s15, 0
  s_cselect_b32 s30, s30, 0
  s_min_u32 s21, s27, 7
  s_add_u32 s15, s21, 1
  v_readlane_b32 s19, v21, s21
  v_readlane_b32 s20, v21, s15
  s_mov_b32 s21, 1023
  s_nop 0
  v_cmp_gt_u32 vcc, s20, v26
  v_cmp_lt_u32_e64 s[94:95], s19, v27
  s_nop 1
  s_and_b32 s31, vcc_lo, s94
  s_and_b32 s31, s31, s21
  s_lshl_b32 s31, s31, 8
  s_or_b32 s31, s31, 255
  s_lshr_b32 s15, s31, s50
  s_and_b32 s15, s15, 1
  s_and_b32 s15, s15, s6
  s_cmp_lg_u32 s15, 0
  s_cselect_b32 s31, s31, 0
  s_mov_b32 s47, 1
  s_cmp_eq_u32 s6, 0
  s_cbranch_scc1 L_sbret_1
  s_branch L_sbret_2
L_other_role:
  s_cmp_lt_u32 s5, 6
  s_cbranch_scc0 L_dyn_role
  s_mov_b32 s0, 0
  s_mov_b32 s50, s5
  s_lshl_b32 s15, s5, 7
  s_add_u32 s8, s15, 5
  s_add_u32 s9, s15, 133
  s_mul_i32 s8, s8, 10923
  s_mul_i32 s9, s9, 10923
  s_lshr_b32 s8, s8, 16
  s_lshr_b32 s9, s9, 16
  s_mov_b32 s6, 1
  s_mov_b32 s7, 0
  s_sub_u32 s15, s9, s8
  s_mul_i32 s10, s15, s3
  s_add_u32 s11, s10, s15
  s_lshr_b32 s10, s10, 2
  s_lshr_b32 s11, s11, 2
  s_sub_u32 s11, s11, s10
  s_add_u32 s10, s10, s8
  s_mov_b32 s91, s10
  s_branch L_k0
L_sh_desc:
  v_lshrrev_b32 v26, 3, v1
  v_and_b32 v27, 7, v1
  v_cmp_gt_u32_e64 s[94:95], s11, v27
  v_add_u32 v27, s10, v27
  v_mov_b32 v28, 0xff0000
  s_mov_b32 s12, 1
  s_branch L_desc_addr
L_dyn_role:
  v_and_b32 v1, 63, v0
  s_lshl_b32 s77, s3, 15
  s_mov_b32 s51, 0
  s_add_u32 s50, s5, -14&0xffffffff
  s_mov_b32 s0, 1
  s_waitcnt lgkmcnt(0)
  s_load_dwordx8 s[60:67], s[24:25], 0
  s_waitcnt lgkmcnt(0)
  s_mov_b32 s68, 0
  s_mov_b32 s15, -3057
  s_min_i32 s60, s60, 4096
  s_add_i32 s14, s60, s15
  s_max_i32 s14, s14, 0
  s_lshr_b32 s14, s14, 4
  s_add_u32 s69, s68, s14
  s_min_i32 s61, s61, 4096
  s_add_i32 s14, s61, s15
  s_max_i32 s14, s14, 0
  s_lshr_b32 s14, s14, 4
  s_add_u32 s70, s69, s14
  s_min_i32 s62, s62, 4096
  s_add_i32 s14, s62, s15
  s_max_i32 s14, s14, 0
  s_lshr_b32 s14, s14, 4
  s_add_u32 s71, s70, s14
  s_min_i32 s63, s63, 4096
  s_add_i32 s14, s63, s15
  s_max_i32 s14, s14, 0
  s_lshr_b32 s14, s14, 4
  s_add_u32 s72, s71, s14
  s_min_i32 s64, s64, 4096
  s_add_i32 s14, s64, s15
  s_max_i32 s14, s14, 0
  s_lshr_b32 s14, s14, 4
  s_add_u32 s73, s72, s14
  s_min_i32 s65, s65, 4096
  s_add_i32 s14, s65, s15
  s_max_i32 s14, s14, 0
  s_lshr_b32 s14, s14, 4
  s_add_u32 s74, s73, s14
  s_min_i32 s66, s66, 4096
  s_add_i32 s14, s66, s15
  s_max_i32 s14, s14, 0
  s_lshr_b32 s14, s14, 4
  s_add_u32 s75, s74, s14
  s_min_i32 s67, s67, 4096
  s_add_i32 s14, s67, s15
  s_max_i32 s14, s14, 0
  s_lshr_b32 s14, s14, 4
  s_add_u32 s76, s75, s14
  s_mov_b32 s15, 9
  s_add_u32 s14, s76, s15
  s_mov_b32 s15, 6554
  s_mul_i32 s14, s14, s15
  s_lshr_b32 s14, s14, 16
  s_sub_u32 s15, s5, 22
  s_mul_i32 s8, s15, s14
  s_add_u32 s9, s8, s14
  s_min_u32 s8, s8, s76
  s_min_u32 s9, s9, s76
  s_cmp_eq_u32 s8, s9
  s_cbranch_scc1 L_end
  s_cmp_ge_u32 s8, s72
  s_cselect_b32 s7, 1, 0
  s_cmp_gt_u32 s9, s72
  s_cselect_b32 s6, 1, 0
  s_andn2_b32 s6, s6, s7
  s_sub_u32 s15, s9, s8
  s_mul_i32 s10, s15, s3
  s_add_u32 s11, s10, s15
  s_lshr_b32 s10, s10, 2
  s_lshr_b32 s11, s11, 2
  s_sub_u32 s11, s11, s10
  s_add_u32 s10, s10, s8
  v_add_u32 v27, s10, v1
  v_cmp_gt_u32_e64 s[94:95], s11, v1
  v_mov_b32 v26, 0
  v_mov_b32 v28, 0
  v_cmp_le_u32_e64 s[96:97], s69, v27
  v_cmp_le_u32_e64 s[98:99], s70, v27
  v_mov_b32 v29, s69
  v_cndmask_b32_e64 v28, v28, v29, s[96:97]
  v_addc_co_u32_e64 v26, vcc, 0, v26, s[96:97]
  v_cmp_le_u32_e64 s[96:97], s71, v27
  v_mov_b32 v29, s70
  v_cndmask_b32_e64 v28, v28, v29, s[98:99]
  v_addc_co_u32_e64 v26, vcc, 0, v26, s[98:99]
  v_cmp_le_u32_e64 s[98:99], s72, v27
  v_mov_b32 v29, s71
  v_cndmask_b32_e64 v28, v28, v29, s[96:97]
  v_addc_co_u32_e64 v26, vcc, 0, v26, s[96:97]
  v_cmp_le_u32_e64 s[96:97], s73, v27
  v_mov_b32 v29, s72
  v_cndmask_b32_e64 v28, v28, v29, s[98:99]
  v_addc_co_u32_e64 v26, vcc, 0, v26, s[98:99]
  v_cmp_le_u32_e64 s[98:99], s74, v27
  v_mov_b32 v29, s73
  v_cndmask_b32_e64 v28, v28, v29, s[96:97]
  v_addc_co_u32_e64 v26, vcc, 0, v26, s[96:97]
  v_cmp_le_u32_e64 s[96:97], s75, v27
  v_mov_b32 v29, s74
  v_cndmask_b32_e64 v28, v28, v29, s[98:99]
  v_addc_co_u32_e64 v26, vcc, 0, v26, s[98:99]
  s_nop 0
  v_mov_b32 v29, s75
  v_cndmask_b32_e64 v28, v28, v29, s[96:97]
  v_addc_co_u32_e64 v26, vcc, 0, v26, s[96:97]
  v_sub_u32 v27, v27, v28
  s_mov_b32 s15, 192
  v_add_u32 v27, s15, v27
  v_add_u32 v28, 16, v26
  v_lshlrev_b32_e64 v28, v28, 1
  s_add_u32 s12, s11, 7
  s_lshr_b32 s12, s12, 3
  s_branch L_desc_addr
L_narrow:
  v_mov_b32 v24, v18
  s_waitcnt vmcnt(15)
  ds_read_b128 a[104:107], v8 offset:0
  ds_read_b128 a[108:111], v9 offset:0
  ds_read_b128 a[112:115], v10 offset:0
  ds_read_b128 a[116:119], v11 offset:0
  s_cmp_ge_u32 s89, 0x10000
  s_cselect_b32 s34, 37748736, 0
  s_mov_b32 s23, s81
  buffer_load_dwordx4 v4, s[32:35], s23 offen nt lds
  s_add_u32 m0, m0, 0x400
  s_add_u32 s23, s23, 0x2000
  buffer_load_dwordx4 v5, s[32:35], s23 offen nt lds
  s_add_u32 m0, m0, 0x400
  s_add_u32 s23, s23, 0x2000
  buffer_load_dwordx4 v6, s[32:35], s23 offen nt lds
  s_add_u32 m0, m0, 0x400
  s_add_u32 s23, s23, 0x2000
  buffer_load_dwordx4 v7, s[32:35], s23 offen nt lds
  s_add_u32 m0, m0, 0x400
  s_waitcnt lgkmcnt(0)
  v_mfma_f32_16x16x32_bf16 v[64:67], a[104:107], a[72:75], 0
  v_mfma_f32_16x16x32_bf16 v[64:67], a[108:111], a[76:79], v[64:67]
  v_mfma_f32_16x16x32_bf16 v[64:67], a[112:115], a[80:83], v[64:67]
  v_mfma_f32_16x16x32_bf16 v[64:67], a[116:119], a[84:87], v[64:67]
  s_bitcmp1_b32 s47, 1
  s_cbranch_scc1 L_setupB
L_sbret_1:
  s_waitcnt vmcnt(13)
  ds_read_b128 a[120:123], v8 offset:4096
  ds_read_b128 a[124:127], v9 offset:4096
  ds_read_b128 a[128:131], v10 offset:4096
  ds_read_b128 a[132:135], v11 offset:4096
  s_cmp_ge_u32 s90, 0x10000
  s_cselect_b32 s34, 37748736, 0
  s_mov_b32 s23, s82
  buffer_load_dwordx4 v4, s[32:35], s23 offen nt lds
  s_add_u32 m0, m0, 0x400
  s_add_u32 s23, s23, 0x2000
  buffer_load_dwordx4 v5, s[32:35], s23 offen nt lds
  s_add_u32 m0, m0, 0x400
  s_add_u32 s23, s23, 0x2000
  buffer_load_dwordx4 v6, s[32:35], s23 offen nt lds
  s_add_u32 m0, m0, 0x400
  s_add_u32 s23, s23, 0x2000
  buffer_load_dwordx4 v7, s[32:35], s23 offen nt lds
  s_add_u32 m0, m0, 0x400
  s_and_b32 s15, s86, 0xffff
  v_and_b32 v26, s86, v16
  v_cmp_ne_u32 vcc, 0, v26
  v_subrev_u32 v27, s15, v14
  s_nop 0
  v_cndmask_b32 v27, -1, v27, vcc
  v_cmp_lt_i32_e64 s[94:95], 0, v27
  v_cmp_lt_i32_e64 s[96:97], 1, v27
  v_cmp_lt_i32_e64 s[98:99], 2, v27
  v_cmp_lt_i32_e64 s[100:101], 3, v27
  v_cndmask_b32_e64 v64, v18, v64, s[94:95]
  v_cndmask_b32_e64 v65, v18, v65, s[96:97]
  v_cndmask_b32_e64 v66, v18, v66, s[98:99]
  v_cndmask_b32_e64 v67, v18, v67, s[100:101]
  v_max3_f32 v24, v64, v65, v24
  v_max3_f32 v24, v66, v67, v24
  s_waitcnt lgkmcnt(0)
  v_mfma_f32_16x16x32_bf16 v[72:75], a[120:123], a[72:75], 0
  v_mfma_f32_16x16x32_bf16 v[72:75], a[124:127], a[76:79], v[72:75]
  v_mfma_f32_16x16x32_bf16 v[72:75], a[128:131], a[80:83], v[72:75]
  v_mfma_f32_16x16x32_bf16 v[72:75], a[132:135], a[84:87], v[72:75]
  s_cmp_le_u32 s1, 2
  s_cbranch_scc1 L_drain2_1
  s_waitcnt vmcnt(13)
  ds_read_b128 a[104:107], v8 offset:8192
  ds_read_b128 a[108:111], v9 offset:8192
  ds_read_b128 a[112:115], v10 offset:8192
  ds_read_b128 a[116:119], v11 offset:8192
  s_cmp_ge_u32 s91, 0x10000
  s_cselect_b32 s34, 37748736, 0
  s_mov_b32 s23, s83
  buffer_load_dwordx4 v4, s[32:35], s23 offen nt lds
  s_add_u32 m0, m0, 0x400
  s_add_u32 s23, s23, 0x2000
  buffer_load_dwordx4 v5, s[32:35], s23 offen nt lds
  s_add_u32 m0, m0, 0x400
  s_add_u32 s23, s23, 0x2000
  buffer_load_dwordx4 v6, s[32:35], s23 offen nt lds
  s_add_u32 m0, m0, 0x400
  s_add_u32 s23, s23, 0x2000
  buffer_load_dwordx4 v7, s[32:35], s23 offen nt lds
  s_add_u32 m0, m0, 0x400
  s_and_b32 s15, s87, 0xffff
  v_and_b32 v26, s87, v16
  v_cmp_ne_u32 vcc, 0, v26
  v_subrev_u32 v27, s15, v14
  s_nop 0
  v_cndmask_b32 v27, -1, v27, vcc
  v_cmp_lt_i32_e64 s[94:95], 0, v27
  v_cmp_lt_i32_e64 s[96:97], 1, v27
  v_cmp_lt_i32_e64 s[98:99], 2, v27
  v_cmp_lt_i32_e64 s[100:101], 3, v27
  v_cndmask_b32_e64 v72, v18, v72, s[94:95]
  v_cndmask_b32_e64 v73, v18, v73, s[96:97]
  v_cndmask_b32_e64 v74, v18, v74, s[98:99]
  v_cndmask_b32_e64 v75, v18, v75, s[100:101]
  v_max3_f32 v24, v72, v73, v24
  v_max3_f32 v24, v74, v75, v24
  s_waitcnt lgkmcnt(0)
  v_mfma_f32_16x16x32_bf16 v[80:83], a[104:107], a[72:75], 0
  v_mfma_f32_16x16x32_bf16 v[80:83], a[108:111], a[76:79], v[80:83]
  v_mfma_f32_16x16x32_bf16 v[80:83], a[112:115], a[80:83], v[80:83]
  v_mfma_f32_16x16x32_bf16 v[80:83], a[116:119], a[84:87], v[80:83]
  s_waitcnt vmcnt(8)
  ds_read_b128 a[120:123], v8 offset:12288
  ds_read_b128 a[124:127], v9 offset:12288
  ds_read_b128 a[128:131], v10 offset:12288
  ds_read_b128 a[132:135], v11 offset:12288
  s_cmp_ge_u32 s92, 0x10000
  s_cselect_b32 s34, 37748736, 0
  s_mov_b32 s23, s84
  buffer_load_dwordx4 v4, s[32:35], s23 offen nt lds
  s_add_u32 m0, m0, 0x400
  s_add_u32 s23, s23, 0x2000
  buffer_load_dwordx4 v5, s[32:35], s23 offen nt lds
  s_add_u32 m0, m0, 0x400
  s_add_u32 s23, s23, 0x2000
  buffer_load_dwordx4 v6, s[32:35], s23 offen nt lds
  s_add_u32 m0, m0, 0x400
  s_add_u32 s23, s23, 0x2000
  buffer_load_dwordx4 v7, s[32:35], s23 offen nt lds
  s_add_u32 m0, m0, 0x400
  s_and_b32 s15, s88, 0xffff
  v_and_b32 v26, s88, v16
  v_cmp_ne_u32 vcc, 0, v26
  v_subrev_u32 v27, s15, v14
  s_nop 0
  v_cndmask_b32 v27, -1, v27, vcc
  v_cmp_lt_i32_e64 s[94:95], 0, v27
  v_cmp_lt_i32_e64 s[96:97], 1, v27
  v_cmp_lt_i32_e64 s[98:99], 2, v27
  v_cmp_lt_i32_e64 s[100:101], 3, v27
  v_cndmask_b32_e64 v80, v18, v80, s[94:95]
  v_cndmask_b32_e64 v81, v18, v81, s[96:97]
  v_cndmask_b32_e64 v82, v18, v82, s[98:99]
  v_cndmask_b32_e64 v83, v18, v83, s[100:101]
  v_max3_f32 v24, v80, v81, v24
  v_max3_f32 v24, v82, v83, v24
  s_waitcnt lgkmcnt(0)
  v_mfma_f32_16x16x32_bf16 v[88:91], a[120:123], a[72:75], 0
  v_mfma_f32_16x16x32_bf16 v[88:91], a[124:127], a[76:79], v[88:91]
  v_mfma_f32_16x16x32_bf16 v[88:91], a[128:131], a[80:83], v[88:91]
  v_mfma_f32_16x16x32_bf16 v[88:91], a[132:135], a[84:87], v[88:91]
  s_cmp_le_u32 s1, 4
  s_cbranch_scc1 L_drain4_1
  s_waitcnt vmcnt(8)
  ds_read_b128 a[104:107], v8 offset:16384
  ds_read_b128 a[108:111], v9 offset:16384
  ds_read_b128 a[112:115], v10 offset:16384
  ds_read_b128 a[116:119], v11 offset:16384
  s_cmp_ge_u32 s93, 0x10000
  s_cselect_b32 s34, 37748736, 0
  s_mov_b32 s23, s85
  buffer_load_dwordx4 v4, s[32:35], s23 offen nt lds
  s_add_u32 m0, m0, 0x400
  s_add_u32 s23, s23, 0x2000
  buffer_load_dwordx4 v5, s[32:35], s23 offen nt lds
  s_add_u32 m0, m0, 0x400
  s_add_u32 s23, s23, 0x2000
  buffer_load_dwordx4 v6, s[32:35], s23 offen nt lds
  s_add_u32 m0, m0, 0x400
  s_add_u32 s23, s23, 0x2000
  buffer_load_dwordx4 v7, s[32:35], s23 offen nt lds
  s_add_u32 m0, m0, 0x400
  s_and_b32 s15, s89, 0xffff
  v_and_b32 v26, s89, v16
  v_cmp_ne_u32 vcc, 0, v26
  v_subrev_u32 v27, s15, v14
  s_nop 0
  v_cndmask_b32 v27, -1, v27, vcc
  v_cmp_lt_i32_e64 s[94:95], 0, v27
  v_cmp_lt_i32_e64 s[96:97], 1, v27
  v_cmp_lt_i32_e64 s[98:99], 2, v27
  v_cmp_lt_i32_e64 s[100:101], 3, v27
  v_cndmask_b32_e64 v88, v18, v88, s[94:95]
  v_cndmask_b32_e64 v89, v18, v89, s[96:97]
  v_cndmask_b32_e64 v90, v18, v90, s[98:99]
  v_cndmask_b32_e64 v91, v18, v91, s[100:101]
  v_max3_f32 v24, v88, v89, v24
  v_max3_f32 v24, v90, v91, v24
  s_waitcnt lgkmcnt(0)
  v_mfma_f32_16x16x32_bf16 v[96:99], a[104:107], a[72:75], 0
  v_mfma_f32_16x16x32_bf16 v[96:99], a[108:111], a[76:79], v[96:99]
  v_mfma_f32_16x16x32_bf16 v[96:99], a[112:115], a[80:83], v[96:99]
  v_mfma_f32_16x16x32_bf16 v[96:99], a[116:119], a[84:87], v[96:99]
  s_waitcnt vmcnt(8)
  ds_read_b128 a[120:123], v8 offset:20480
  ds_read_b128 a[124:127], v9 offset:20480
  ds_read_b128 a[128:131], v10 offset:20480
  ds_read_b128 a[132:135], v11 offset:20480
  s_cmp_ge_u32 s86, 0x10000
  s_cselect_b32 s38, 37748736, 0
  buffer_load_dwordx4 v[128:131], v12, s[36:39], s78 offen offset:0 nt
  buffer_load_dwordx4 v[132:135], v12, s[36:39], s78 offen offset:2048 nt
  buffer_load_dwordx4 v[136:139], v13, s[36:39], s78 offen offset:0 nt
  buffer_load_dwordx4 v[140:143], v13, s[36:39], s78 offen offset:2048 nt
  s_and_b32 s15, s90, 0xffff
  v_and_b32 v26, s90, v16
  v_cmp_ne_u32 vcc, 0, v26
  v_subrev_u32 v27, s15, v14
  s_nop 0
  v_cndmask_b32 v27, -1, v27, vcc
  v_cmp_lt_i32_e64 s[94:95], 0, v27
  v_cmp_lt_i32_e64 s[96:97], 1, v27
  v_cmp_lt_i32_e64 s[98:99], 2, v27
  v_cmp_lt_i32_e64 s[100:101], 3, v27
  v_cndmask_b32_e64 v96, v18, v96, s[94:95]
  v_cndmask_b32_e64 v97, v18, v97, s[96:97]
  v_cndmask_b32_e64 v98, v18, v98, s[98:99]
  v_cndmask_b32_e64 v99, v18, v99, s[100:101]
  v_max3_f32 v24, v96, v97, v24
  v_max3_f32 v24, v98, v99, v24
  s_waitcnt lgkmcnt(0)
  v_mfma_f32_16x16x32_bf16 v[104:107], a[120:123], a[72:75], 0
  v_mfma_f32_16x16x32_bf16 v[104:107], a[124:127], a[76:79], v[104:107]
  v_mfma_f32_16x16x32_bf16 v[104:107], a[128:131], a[80:83], v[104:107]
  v_mfma_f32_16x16x32_bf16 v[104:107], a[132:135], a[84:87], v[104:107]
  s_cmp_le_u32 s1, 6
  s_cbranch_scc1 L_drain6_1
  s_waitcnt vmcnt(8)
  ds_read_b128 a[104:107], v8 offset:24576
  ds_read_b128 a[108:111], v9 offset:24576
  ds_read_b128 a[112:115], v10 offset:24576
  ds_read_b128 a[116:119], v11 offset:24576
  s_cmp_ge_u32 s87, 0x10000
  s_cselect_b32 s38, 37748736, 0
  buffer_load_dwordx4 v[144:147], v12, s[36:39], s79 offen offset:0 nt
  buffer_load_dwordx4 v[148:151], v12, s[36:39], s79 offen offset:2048 nt
  buffer_load_dwordx4 v[152:155], v13, s[36:39], s79 offen offset:0 nt
  buffer_load_dwordx4 v[156:159], v13, s[36:39], s79 offen offset:2048 nt
  s_and_b32 s15, s91, 0xffff
  v_and_b32 v26, s91, v16
  v_cmp_ne_u32 vcc, 0, v26
  v_subrev_u32 v27, s15, v14
  s_nop 0
  v_cndmask_b32 v27, -1, v27, vcc
  v_cmp_lt_i32_e64 s[94:95], 0, v27
  v_cmp_lt_i32_e64 s[96:97], 1, v27
  v_cmp_lt_i32_e64 s[98:99], 2, v27
  v_cmp_lt_i32_e64 s[100:101], 3, v27
  v_cndmask_b32_e64 v104, v18, v104, s[94:95]
  v_cndmask_b32_e64 v105, v18, v105, s[96:97]
  v_cndmask_b32_e64 v106, v18, v106, s[98:99]
  v_cndmask_b32_e64 v107, v18, v107, s[100:101]
  v_max3_f32 v24, v104, v105, v24
  v_max3_f32 v24, v106, v107, v24
  s_waitcnt lgkmcnt(0)
  v_mfma_f32_16x16x32_bf16 v[112:115], a[104:107], a[72:75], 0
  v_mfma_f32_16x16x32_bf16 v[112:115], a[108:111], a[76:79], v[112:115]
  v_mfma_f32_16x16x32_bf16 v[112:115], a[112:115], a[80:83], v[112:115]
  v_mfma_f32_16x16x32_bf16 v[112:115], a[116:119], a[84:87], v[112:115]
  s_waitcnt vmcnt(8)
  ds_read_b128 a[120:123], v8 offset:28672
  ds_read_b128 a[124:127], v9 offset:28672
  ds_read_b128 a[128:131], v10 offset:28672
  ds_read_b128 a[132:135], v11 offset:28672
  s_cmp_ge_u32 s88, 0x10000
  s_cselect_b32 s38, 37748736, 0
  buffer_load_dwordx4 v[160:163], v12, s[36:39], s80 offen offset:0 nt
  buffer_load_dwordx4 v[164:167], v12, s[36:39], s80 offen offset:2048 nt
  buffer_load_dwordx4 v[168:171], v13, s[36:39], s80 offen offset:0 nt
  buffer_load_dwordx4 v[172:175], v13, s[36:39], s80 offen offset:2048 nt
  s_and_b32 s15, s92, 0xffff
  v_and_b32 v26, s92, v16
  v_cmp_ne_u32 vcc, 0, v26
  v_subrev_u32 v27, s15, v14
  s_nop 0
  v_cndmask_b32 v27, -1, v27, vcc
  v_cmp_lt_i32_e64 s[94:95], 0, v27
  v_cmp_lt_i32_e64 s[96:97], 1, v27
  v_cmp_lt_i32_e64 s[98:99], 2, v27
  v_cmp_lt_i32_e64 s[100:101], 3, v27
  v_cndmask_b32_e64 v112, v18, v112, s[94:95]
  v_cndmask_b32_e64 v113, v18, v113, s[96:97]
  v_cndmask_b32_e64 v114, v18, v114, s[98:99]
  v_cndmask_b32_e64 v115, v18, v115, s[100:101]
  v_max3_f32 v24, v112, v113, v24
  v_max3_f32 v24, v114, v115, v24
  s_waitcnt lgkmcnt(0)
  v_mfma_f32_16x16x32_bf16 v[120:123], a[120:123], a[72:75], 0
  v_mfma_f32_16x16x32_bf16 v[120:123], a[124:127], a[76:79], v[120:123]
  v_mfma_f32_16x16x32_bf16 v[120:123], a[128:131], a[80:83], v[120:123]
  v_mfma_f32_16x16x32_bf16 v[120:123], a[132:135], a[84:87], v[120:123]
  s_cmp_ge_u32 s89, 0x10000
  s_cselect_b32 s38, 37748736, 0
  buffer_load_dwordx4 v[176:179], v12, s[36:39], s81 offen offset:0 nt
  buffer_load_dwordx4 v[180:183], v12, s[36:39], s81 offen offset:2048 nt
  buffer_load_dwordx4 v[184:187], v13, s[36:39], s81 offen offset:0 nt
  buffer_load_dwordx4 v[188:191], v13, s[36:39], s81 offen offset:2048 nt
  s_nop 1
  s_and_b32 s15, s93, 0xffff
  v_and_b32 v26, s93, v16
  v_cmp_ne_u32 vcc, 0, v26
  v_subrev_u32 v27, s15, v14
  s_nop 0
  v_cndmask_b32 v27, -1, v27, vcc
  v_cmp_lt_i32_e64 s[94:95], 0, v27
  v_cmp_lt_i32_e64 s[96:97], 1, v27
  v_cmp_lt_i32_e64 s[98:99], 2, v27
  v_cmp_lt_i32_e64 s[100:101], 3, v27
  v_cndmask_b32_e64 v120, v18, v120, s[94:95]
  v_cndmask_b32_e64 v121, v18, v121, s[96:97]
  v_cndmask_b32_e64 v122, v18, v122, s[98:99]
  v_cndmask_b32_e64 v123, v18, v123, s[100:101]
  v_max3_f32 v24, v120, v121, v24
  v_max3_f32 v24, v122, v123, v24
L_join_1:
  s_bitcmp1_b32 s47, 0
  s_cbranch_scc0 L_valid_1
  s_mov_b32 s15, 0x10000
  v_cmp_le_u32_e64 s[94:95], s15, v20
  v_cmp_ne_u32 vcc, v62, v63
  s_mov_b32 s47, 0
  s_nop 0
  s_and_b64 vcc, vcc, s[94:95]
  s_cbranch_vccnz L_fix
L_valid_1:
  s_lshl_b32 s15, s4, 5
  s_load_dwordx8 s[64:71], s[48:49], s15
  v_mov_b32 v26, v24
  s_nop 1
  v_permlane16_swap_b32 v24, v26
  s_nop 0
  v_max_f32 v24, v24, v26
  v_mov_b32 v26, v24
  s_nop 1
  v_permlane32_swap_b32 v24, v26
  s_nop 0
  v_max_f32 v24, v24, v26
  v_mul_f32 v24, s16, v24
  v_max_f32 v24, v24, v22
  s_cmp_eq_u32 s13, 0
  s_cbranch_scc1 L_norescale_8
  v_sub_f32 v26, v22, v24
  v_exp_f32 v26, v26
  s_nop 0
  v_accvgpr_read_b32 v27, a0
  v_mul_f32 v27, v27, v26
  v_accvgpr_write_b32 a0, v27
  v_accvgpr_read_b32 v27, a1
  v_mul_f32 v27, v27, v26
  v_accvgpr_write_b32 a1, v27
  v_accvgpr_read_b32 v27, a2
  v_mul_f32 v27, v27, v26
  v_accvgpr_write_b32 a2, v27
  v_accvgpr_read_b32 v27, a3
  v_mul_f32 v27, v27, v26
  v_accvgpr_write_b32 a3, v27
  v_accvgpr_read_b32 v27, a4
  v_mul_f32 v27, v27, v26
  v_accvgpr_write_b32 a4, v27
  v_accvgpr_read_b32 v27, a5
  v_mul_f32 v27, v27, v26
  v_accvgpr_write_b32 a5, v27
  v_accvgpr_read_b32 v27, a6
  v_mul_f32 v27, v27, v26
  v_accvgpr_write_b32 a6, v27
  v_accvgpr_read_b32 v27, a7
  v_mul_f32 v27, v27, v26
  v_accvgpr_write_b32 a7, v27
  v_accvgpr_read_b32 v27, a8
  v_mul_f32 v27, v27, v26
  v_accvgpr_write_b32 a8, v27
  v_accvgpr_read_b32 v27, a9
  v_mul_f32 v27, v27, v26
  v_accvgpr_write_b32 a9, v27
  v_accvgpr_read_b32 v27, a10
  v_mul_f32 v27, v27, v26
  v_accvgpr_write_b32 a10, v27
  v_accvgpr_read_b32 v27, a11
  v_mul_f32 v27, v27, v26
  v_accvgpr_write_b32 a11, v27
  v_accvgpr_read_b32 v27, a12
  v_mul_f32 v27, v27, v26
  v_accvgpr_write_b32 a12, v27
  v_accvgpr_read_b32 v27, a13
  v_mul_f32 v27, v27, v26
  v_accvgpr_write_b32 a13, v27
  v_accvgpr_read_b32 v27, a14
  v_mul_f32 v27, v27, v26
  v_accvgpr_write_b32 a14, v27
  v_accvgpr_read_b32 v27, a15
  v_mul_f32 v27, v27, v26
  v_accvgpr_write_b32 a15, v27
  v_accvgpr_read_b32 v27, a16
  v_mul_f32 v27, v27, v26
  v_accvgpr_write_b32 a16, v27
  v_accvgpr_read_b32 v27, a17
  v_mul_f32 v27, v27, v26
  v_accvgpr_write_b32 a17, v27
  v_accvgpr_read_b32 v27, a18
  v_mul_f32 v27, v27, v26
  v_accvgpr_write_b32 a18, v27
  v_accvgpr_read_b32 v27, a19
  v_mul_f32 v27, v27, v26
  v_accvgpr_write_b32 a19, v27
  v_accvgpr_read_b32 v27, a20
  v_mul_f32 v27, v27, v26
  v_accvgpr_write_b32 a20, v27
  v_accvgpr_read_b32 v27, a21
  v_mul_f32 v27, v27, v26
  v_accvgpr_write_b32 a21, v27
  v_accvgpr_read_b32 v27, a22
  v_mul_f32 v27, v27, v26
  v_accvgpr_write_b32 a22, v27
  v_accvgpr_read_b32 v27, a23
  v_mul_f32 v27, v27, v26
  v_accvgpr_write_b32 a23, v27
  v_accvgpr_read_b32 v27, a24
  v_mul_f32 v27, v27, v26
  v_accvgpr_write_b32 a24, v27
  v_accvgpr_read_b32 v27, a25
  v_mul_f32 v27, v27, v26
  v_accvgpr_write_b32 a25, v27
  v_accvgpr_read_b32 v27, a26
  v_mul_f32 v27, v27, v26
  v_accvgpr_write_b32 a26, v27
  v_accvgpr_read_b32 v27, a27
  v_mul_f32 v27, v27, v26
  v_accvgpr_write_b32 a27, v27
  v_accvgpr_read_b32 v27, a28
  v_mul_f32 v27, v27, v26
  v_accvgpr_write_b32 a28, v27
  v_accvgpr_read_b32 v27, a29
  v_mul_f32 v27, v27, v26
  v_accvgpr_write_b32 a29, v27
  v_accvgpr_read_b32 v27, a30
  v_mul_f32 v27, v27, v26
  v_accvgpr_write_b32 a30, v27
  v_accvgpr_read_b32 v27, a31
  v_mul_f32 v27, v27, v26
  v_accvgpr_write_b32 a31, v27
  v_accvgpr_read_b32 v27, a64
  v_mul_f32 v27, v27, v26
  v_accvgpr_write_b32 a64, v27
  v_accvgpr_read_b32 v27, a65
  v_mul_f32 v27, v27, v26
  v_accvgpr_write_b32 a65, v27
  v_accvgpr_read_b32 v27, a66
  v_mul_f32 v27, v27, v26
  v_accvgpr_write_b32 a66, v27
  v_accvgpr_read_b32 v27, a67
  v_mul_f32 v27, v27, v26
  v_accvgpr_write_b32 a67, v27
L_norescale_8:
  v_mov_b32 v22, v24
  v_mov_b32 v26, 0xee013f39
  v_cmp_lt_f32 vcc, v24, v26
  s_nop 1
  v_cndmask_b32_e64 v24, v24, 0, vcc
  s_cmp_ge_u32 s90, 0x10000
  s_cselect_b32 s38, 37748736, 0
  buffer_load_dwordx4 v[192:195], v12, s[36:39], s82 offen offset:0 nt
  buffer_load_dwordx4 v[196:199], v12, s[36:39], s82 offen offset:2048 nt
  buffer_load_dwordx4 v[200:203], v13, s[36:39], s82 offen offset:0 nt
  buffer_load_dwordx4 v[204:207], v13, s[36:39], s82 offen offset:2048 nt
  v_fma_f32 v64, v64, s16, -v24
  v_fma_f32 v65, v65, s16, -v24
  v_fma_f32 v66, v66, s16, -v24
  v_fma_f32 v67, v67, s16, -v24
  v_exp_f32 v64, v64
  v_exp_f32 v65, v65
  v_exp_f32 v66, v66
  v_exp_f32 v67, v67
  v_fma_f32 v72, v72, s16, -v24
  v_fma_f32 v73, v73, s16, -v24
  v_fma_f32 v74, v74, s16, -v24
  v_fma_f32 v75, v75, s16, -v24
  v_exp_f32 v72, v72
  v_exp_f32 v73, v73
  v_exp_f32 v74, v74
  v_exp_f32 v75, v75
  s_nop 0
  v_cvt_pk_bf16_f32 v64, v64, v65
  v_cvt_pk_bf16_f32 v65, v66, v67
  v_cvt_pk_bf16_f32 v66, v72, v73
  v_cvt_pk_bf16_f32 v67, v74, v75
  s_cmp_le_u32 s1, 2
  s_cbranch_scc1 L_skip_9
  v_fma_f32 v80, v80, s16, -v24
  v_fma_f32 v81, v81, s16, -v24
  v_fma_f32 v82, v82, s16, -v24
  v_fma_f32 v83, v83, s16, -v24
  v_exp_f32 v80, v80
  v_exp_f32 v81, v81
  v_exp_f32 v82, v82
  v_exp_f32 v83, v83
  v_fma_f32 v88, v88, s16, -v24
  v_fma_f32 v89, v89, s16, -v24
  v_fma_f32 v90, v90, s16, -v24
  v_fma_f32 v91, v91, s16, -v24
  v_exp_f32 v88, v88
  v_exp_f32 v89, v89
  v_exp_f32 v90, v90
  v_exp_f32 v91, v91
  s_nop 0
  v_cvt_pk_bf16_f32 v80, v80, v81
  v_cvt_pk_bf16_f32 v81, v82, v83
  v_cvt_pk_bf16_f32 v82, v88, v89
  v_cvt_pk_bf16_f32 v83, v90, v91
L_skip_9:
  s_cmp_ge_u32 s91, 0x10000
  s_cselect_b32 s38, 37748736, 0
  buffer_load_dwordx4 v[208:211], v12, s[36:39], s83 offen offset:0 nt
  buffer_load_dwordx4 v[212:215], v12, s[36:39], s83 offen offset:2048 nt
  buffer_load_dwordx4 v[216:219], v13, s[36:39], s83 offen offset:0 nt
  buffer_load_dwordx4 v[220:223], v13, s[36:39], s83 offen offset:2048 nt
  s_waitcnt vmcnt(16)
  v_perm_b32 v32, v132, v128, s17
  v_perm_b32 v33, v140, v136, s17
  v_perm_b32 v34, v148, v144, s17
  v_perm_b32 v35, v156, v152, s17
  v_perm_b32 v36, v132, v128, s18
  v_perm_b32 v37, v140, v136, s18
  v_perm_b32 v38, v148, v144, s18
  v_perm_b32 v39, v156, v152, s18
  v_mfma_f32_16x16x32_bf16 a[0:3], v[32:35], v[64:67], a[0:3]
  v_perm_b32 v40, v133, v129, s17
  v_perm_b32 v41, v141, v137, s17
  v_perm_b32 v42, v149, v145, s17
  v_perm_b32 v43, v157, v153, s17
  v_mfma_f32_16x16x32_bf16 a[4:7], v[36:39], v[64:67], a[4:7]
  v_perm_b32 v44, v133, v129, s18
  v_perm_b32 v45, v141, v137, s18
  v_perm_b32 v46, v149, v145, s18
  v_perm_b32 v47, v157, v153, s18
  v_mfma_f32_16x16x32_bf16 a[8:11], v[40:43], v[64:67], a[8:11]
  v_perm_b32 v48, v134, v130, s17
  v_perm_b32 v49, v142, v138, s17
  v_perm_b32 v50, v150, v146, s17
  v_perm_b32 v51, v158, v154, s17
  v_mfma_f32_16x16x32_bf16 a[12:15], v[44:47], v[64:67], a[12:15]
  v_perm_b32 v52, v134, v130, s18
  v_perm_b32 v53, v142, v138, s18
  v_perm_b32 v54, v150, v146, s18
  v_perm_b32 v55, v158, v154, s18
  v_mfma_f32_16x16x32_bf16 a[16:19], v[48:51], v[64:67], a[16:19]
  v_perm_b32 v56, v135, v131, s17
  v_perm_b32 v57, v143, v139, s17
  v_perm_b32 v58, v151, v147, s17
  v_perm_b32 v59, v159, v155, s17
  v_mfma_f32_16x16x32_bf16 a[20:23], v[52:55], v[64:67], a[20:23]
  v_perm_b32 v60, v135, v131, s18
  v_perm_b32 v61, v143, v139, s18
  v_perm_b32 v62, v151, v147, s18
  v_perm_b32 v63, v159, v155, s18
  v_mfma_f32_16x16x32_bf16 a[24:27], v[56:59], v[64:67], a[24:27]
  v_mfma_f32_16x16x32_bf16 a[64:67], a[136:139], v[64:67], a[64:67]
  s_nop 0
  v_mfma_f32_16x16x32_bf16 a[28:31], v[60:63], v[64:67], a[28:31]
  s_cmp_le_u32 s1, 4
  s_cbranch_scc1 L_skip_10
  v_fma_f32 v96, v96, s16, -v24
  v_fma_f32 v97, v97, s16, -v24
  v_fma_f32 v98, v98, s16, -v24
  v_fma_f32 v99, v99, s16, -v24
  v_exp_f32 v96, v96
  v_exp_f32 v97, v97
  v_exp_f32 v98, v98
  v_exp_f32 v99, v99
  v_fma_f32 v104, v104, s16, -v24
  v_fma_f32 v105, v105, s16, -v24
  v_fma_f32 v106, v106, s16, -v24
  v_fma_f32 v107, v107, s16, -v24
  v_exp_f32 v104, v104
  v_exp_f32 v105, v105
  v_exp_f32 v106, v106
  v_exp_f32 v107, v107
  s_nop 0
  v_cvt_pk_bf16_f32 v96, v96, v97
  v_cvt_pk_bf16_f32 v97, v98, v99
  v_cvt_pk_bf16_f32 v98, v104, v105
  v_cvt_pk_bf16_f32 v99, v106, v107
L_skip_10:
  s_cmp_ge_u32 s92, 0x10000
  s_cselect_b32 s38, 37748736, 0
  buffer_load_dwordx4 v[224:227], v12, s[36:39], s84 offen offset:0 nt
  buffer_load_dwordx4 v[228:231], v12, s[36:39], s84 offen offset:2048 nt
  buffer_load_dwordx4 v[232:235], v13, s[36:39], s84 offen offset:0 nt
  buffer_load_dwordx4 v[236:239], v13, s[36:39], s84 offen offset:2048 nt
  s_cmp_le_u32 s1, 6
  s_cbranch_scc1 L_skip_11
  v_fma_f32 v112, v112, s16, -v24
  v_fma_f32 v113, v113, s16, -v24
  v_fma_f32 v114, v114, s16, -v24
  v_fma_f32 v115, v115, s16, -v24
  v_exp_f32 v112, v112
  v_exp_f32 v113, v113
  v_exp_f32 v114, v114
  v_exp_f32 v115, v115
  v_fma_f32 v120, v120, s16, -v24
  v_fma_f32 v121, v121, s16, -v24
  v_fma_f32 v122, v122, s16, -v24
  v_fma_f32 v123, v123, s16, -v24
  v_exp_f32 v120, v120
  v_exp_f32 v121, v121
  v_exp_f32 v122, v122
  v_exp_f32 v123, v123
  s_nop 0
  v_cvt_pk_bf16_f32 v112, v112, v113
  v_cvt_pk_bf16_f32 v113, v114, v115
  v_cvt_pk_bf16_f32 v114, v120, v121
  v_cvt_pk_bf16_f32 v115, v122, v123
L_skip_11:
  s_cmp_le_u32 s1, 2
  s_cbranch_scc1 L_skip_12
  s_waitcnt vmcnt(12)
  v_perm_b32 v32, v164, v160, s17
  v_perm_b32 v33, v172, v168, s17
  v_perm_b32 v34, v180, v176, s17
  v_perm_b32 v35, v188, v184, s17
  v_perm_b32 v36, v164, v160, s18
  v_perm_b32 v37, v172, v168, s18
  v_perm_b32 v38, v180, v176, s18
  v_perm_b32 v39, v188, v184, s18
  v_mfma_f32_16x16x32_bf16 a[0:3], v[32:35], v[80:83], a[0:3]
  v_perm_b32 v40, v165, v161, s17
  v_perm_b32 v41, v173, v169, s17
  v_perm_b32 v42, v181, v177, s17
  v_perm_b32 v43, v189, v185, s17
  v_mfma_f32_16x16x32_bf16 a[4:7], v[36:39], v[80:83], a[4:7]
  v_perm_b32 v44, v165, v161, s18
  v_perm_b32 v45, v173, v169, s18
  v_perm_b32 v46, v181, v177, s18
  v_perm_b32 v47, v189, v185, s18
  v_mfma_f32_16x16x32_bf16 a[8:11], v[40:43], v[80:83], a[8:11]
  v_perm_b32 v48, v166, v162, s17
  v_perm_b32 v49, v174, v170, s17
  v_perm_b32 v50, v182, v178, s17
  v_perm_b32 v51, v190, v186, s17
  v_mfma_f32_16x16x32_bf16 a[12:15], v[44:47], v[80:83], a[12:15]
  v_perm_b32 v52, v166, v162, s18
  v_perm_b32 v53, v174, v170, s18
  v_perm_b32 v54, v182, v178, s18
  v_perm_b32 v55, v190, v186, s18
  v_mfma_f32_16x16x32_bf16 a[16:19], v[48:51], v[80:83], a[16:19]
  v_perm_b32 v56, v167, v163, s17
  v_perm_b32 v57, v175, v171, s17
  v_perm_b32 v58, v183, v179, s17
  v_perm_b32 v59, v191, v187, s17
  v_mfma_f32_16x16x32_bf16 a[20:23], v[52:55], v[80:83], a[20:23]
  v_perm_b32 v60, v167, v163, s18
  v_perm_b32 v61, v175, v171, s18
  v_perm_b32 v62, v183, v179, s18
  v_perm_b32 v63, v191, v187, s18
  v_mfma_f32_16x16x32_bf16 a[24:27], v[56:59], v[80:83], a[24:27]
  v_mfma_f32_16x16x32_bf16 a[64:67], a[136:139], v[80:83], a[64:67]
  s_nop 0
  v_mfma_f32_16x16x32_bf16 a[28:31], v[60:63], v[80:83], a[28:31]
L_skip_12:
  s_cmp_ge_u32 s93, 0x10000
  s_cselect_b32 s38, 37748736, 0
  buffer_load_dwordx4 v[240:243], v12, s[36:39], s85 offen offset:0 nt
  buffer_load_dwordx4 v[244:247], v12, s[36:39], s85 offen offset:2048 nt
  buffer_load_dwordx4 v[248:251], v13, s[36:39], s85 offen offset:0 nt
  buffer_load_dwordx4 v[252:255], v13, s[36:39], s85 offen offset:2048 nt
  s_cmp_le_u32 s1, 4
  s_cbranch_scc1 L_skip_13
  s_waitcnt vmcnt(8)
  v_perm_b32 v32, v196, v192, s17
  v_perm_b32 v33, v204, v200, s17
  v_perm_b32 v34, v212, v208, s17
  v_perm_b32 v35, v220, v216, s17
  v_perm_b32 v36, v196, v192, s18
  v_perm_b32 v37, v204, v200, s18
  v_perm_b32 v38, v212, v208, s18
  v_perm_b32 v39, v220, v216, s18
  v_mfma_f32_16x16x32_bf16 a[0:3], v[32:35], v[96:99], a[0:3]
  v_perm_b32 v40, v197, v193, s17
  v_perm_b32 v41, v205, v201, s17
  v_perm_b32 v42, v213, v209, s17
  v_perm_b32 v43, v221, v217, s17
  v_mfma_f32_16x16x32_bf16 a[4:7], v[36:39], v[96:99], a[4:7]
  v_perm_b32 v44, v197, v193, s18
  v_perm_b32 v45, v205, v201, s18
  v_perm_b32 v46, v213, v209, s18
  v_perm_b32 v47, v221, v217, s18
  v_mfma_f32_16x16x32_bf16 a[8:11], v[40:43], v[96:99], a[8:11]
  v_perm_b32 v48, v198, v194, s17
  v_perm_b32 v49, v206, v202, s17
  v_perm_b32 v50, v214, v210, s17
  v_perm_b32 v51, v222, v218, s17
  v_mfma_f32_16x16x32_bf16 a[12:15], v[44:47], v[96:99], a[12:15]
  v_perm_b32 v52, v198, v194, s18
  v_perm_b32 v53, v206, v202, s18
  v_perm_b32 v54, v214, v210, s18
  v_perm_b32 v55, v222, v218, s18
  v_mfma_f32_16x16x32_bf16 a[16:19], v[48:51], v[96:99], a[16:19]
  v_perm_b32 v56, v199, v195, s17
  v_perm_b32 v57, v207, v203, s17
  v_perm_b32 v58, v215, v211, s17
  v_perm_b32 v59, v223, v219, s17
  v_mfma_f32_16x16x32_bf16 a[20:23], v[52:55], v[96:99], a[20:23]
  v_perm_b32 v60, v199, v195, s18
  v_perm_b32 v61, v207, v203, s18
  v_perm_b32 v62, v215, v211, s18
  v_perm_b32 v63, v223, v219, s18
  v_mfma_f32_16x16x32_bf16 a[24:27], v[56:59], v[96:99], a[24:27]
  v_mfma_f32_16x16x32_bf16 a[64:67], a[136:139], v[96:99], a[64:67]
  s_nop 0
  v_mfma_f32_16x16x32_bf16 a[28:31], v[60:63], v[96:99], a[28:31]
L_skip_13:
  s_cmp_le_u32 s1, 6
  s_cbranch_scc1 L_skip_14
  s_waitcnt vmcnt(0)
  v_perm_b32 v32, v228, v224, s17
  v_perm_b32 v33, v236, v232, s17
  v_perm_b32 v34, v244, v240, s17
  v_perm_b32 v35, v252, v248, s17
  v_perm_b32 v36, v228, v224, s18
  v_perm_b32 v37, v236, v232, s18
  v_perm_b32 v38, v244, v240, s18
  v_perm_b32 v39, v252, v248, s18
  v_mfma_f32_16x16x32_bf16 a[0:3], v[32:35], v[112:115], a[0:3]
  v_perm_b32 v40, v229, v225, s17
  v_perm_b32 v41, v237, v233, s17
  v_perm_b32 v42, v245, v241, s17
  v_perm_b32 v43, v253, v249, s17
  v_mfma_f32_16x16x32_bf16 a[4:7], v[36:39], v[112:115], a[4:7]
  v_perm_b32 v44, v229, v225, s18
  v_perm_b32 v45, v237, v233, s18
  v_perm_b32 v46, v245, v241, s18
  v_perm_b32 v47, v253, v249, s18
  v_mfma_f32_16x16x32_bf16 a[8:11], v[40:43], v[112:115], a[8:11]
  v_perm_b32 v48, v230, v226, s17
  v_perm_b32 v49, v238, v234, s17
  v_perm_b32 v50, v246, v242, s17
  v_perm_b32 v51, v254, v250, s17
  v_mfma_f32_16x16x32_bf16 a[12:15], v[44:47], v[112:115], a[12:15]
  v_perm_b32 v52, v230, v226, s18
  v_perm_b32 v53, v238, v234, s18
  v_perm_b32 v54, v246, v242, s18
  v_perm_b32 v55, v254, v250, s18
  v_mfma_f32_16x16x32_bf16 a[16:19], v[48:51], v[112:115], a[16:19]
  v_perm_b32 v56, v231, v227, s17
  v_perm_b32 v57, v239, v235, s17
  v_perm_b32 v58, v247, v243, s17
  v_perm_b32 v59, v255, v251, s17
  v_mfma_f32_16x16x32_bf16 a[20:23], v[52:55], v[112:115], a[20:23]
  v_perm_b32 v60, v231, v227, s18
  v_perm_b32 v61, v239, v235, s18
  v_perm_b32 v62, v247, v243, s18
  v_perm_b32 v63, v255, v251, s18
  v_mfma_f32_16x16x32_bf16 a[24:27], v[56:59], v[112:115], a[24:27]
  v_mfma_f32_16x16x32_bf16 a[64:67], a[136:139], v[112:115], a[64:67]
  s_nop 0
  v_mfma_f32_16x16x32_bf16 a[28:31], v[60:63], v[112:115], a[28:31]
L_skip_14:
  s_add_u32 s13, s13, 1
  s_cmp_lt_u32 s13, s12
  s_nop 7
  s_cbranch_scc1 L_nextround
  v_add_u32 v26, 0, v3
  v_mul_u32_u24 v26, 520, v26
  v_add_u32 v26, s77, v26
  v_lshl_add_u32 v27, v2, 7, v26
  ds_write2_b32 v27, a0, a4 offset0:0 offset1:1
  ds_write2_b32 v27, a8, a12 offset0:2 offset1:3
  ds_write2_b32 v27, a16, a20 offset0:4 offset1:5
  ds_write2_b32 v27, a24, a28 offset0:6 offset1:7
  ds_write2_b32 v27, a1, a5 offset0:8 offset1:9
  ds_write2_b32 v27, a9, a13 offset0:10 offset1:11
  ds_write2_b32 v27, a17, a21 offset0:12 offset1:13
  ds_write2_b32 v27, a25, a29 offset0:14 offset1:15
  ds_write2_b32 v27, a2, a6 offset0:16 offset1:17
  ds_write2_b32 v27, a10, a14 offset0:18 offset1:19
  ds_write2_b32 v27, a18, a22 offset0:20 offset1:21
  ds_write2_b32 v27, a26, a30 offset0:22 offset1:23
  ds_write2_b32 v27, a3, a7 offset0:24 offset1:25
  ds_write2_b32 v27, a11, a15 offset0:26 offset1:27
  ds_write2_b32 v27, a19, a23 offset0:28 offset1:29
  ds_write2_b32 v27, a27, a31 offset0:30 offset1:31
  ds_write_b32 v26, v22 offset:512
  ds_write_b32 v26, a64 offset:516
  s_branch L_tail
L_drain2_1:
  s_cmp_ge_u32 s91, 0x10000
  s_cselect_b32 s34, 37748736, 0
  s_mov_b32 s23, s83
  buffer_load_dwordx4 v4, s[32:35], s23 offen nt lds
  s_add_u32 m0, m0, 0x400
  s_add_u32 s23, s23, 0x2000
  buffer_load_dwordx4 v5, s[32:35], s23 offen nt lds
  s_add_u32 m0, m0, 0x400
  s_add_u32 s23, s23, 0x2000
  buffer_load_dwordx4 v6, s[32:35], s23 offen nt lds
  s_add_u32 m0, m0, 0x400
  s_add_u32 s23, s23, 0x2000
  buffer_load_dwordx4 v7, s[32:35], s23 offen nt lds
  s_add_u32 m0, m0, 0x400
  s_cmp_ge_u32 s92, 0x10000
  s_cselect_b32 s34, 37748736, 0
  s_mov_b32 s23, s84
  buffer_load_dwordx4 v4, s[32:35], s23 offen nt lds
  s_add_u32 m0, m0, 0x400
  s_add_u32 s23, s23, 0x2000
  buffer_load_dwordx4 v5, s[32:35], s23 offen nt lds
  s_add_u32 m0, m0, 0x400
  s_add_u32 s23, s23, 0x2000
  buffer_load_dwordx4 v6, s[32:35], s23 offen nt lds
  s_add_u32 m0, m0, 0x400
  s_add_u32 s23, s23, 0x2000
  buffer_load_dwordx4 v7, s[32:35], s23 offen nt lds
  s_add_u32 m0, m0, 0x400
  s_cmp_ge_u32 s93, 0x10000
  s_cselect_b32 s34, 37748736, 0
  s_mov_b32 s23, s85
  buffer_load_dwordx4 v4, s[32:35], s23 offen nt lds
  s_add_u32 m0, m0, 0x400
  s_add_u32 s23, s23, 0x2000
  buffer_load_dwordx4 v5, s[32:35], s23 offen nt lds
  s_add_u32 m0, m0, 0x400
  s_add_u32 s23, s23, 0x2000
  buffer_load_dwordx4 v6, s[32:35], s23 offen nt lds
  s_add_u32 m0, m0, 0x400
  s_add_u32 s23, s23, 0x2000
  buffer_load_dwordx4 v7, s[32:35], s23 offen nt lds
  s_add_u32 m0, m0, 0x400
  s_cmp_ge_u32 s86, 0x10000
  s_cselect_b32 s38, 37748736, 0
  buffer_load_dwordx4 v[128:131], v12, s[36:39], s78 offen offset:0 nt
  buffer_load_dwordx4 v[132:135], v12, s[36:39], s78 offen offset:2048 nt
  buffer_load_dwordx4 v[136:139], v13, s[36:39], s78 offen offset:0 nt
  buffer_load_dwordx4 v[140:143], v13, s[36:39], s78 offen offset:2048 nt
  s_cmp_ge_u32 s87, 0x10000
  s_cselect_b32 s38, 37748736, 0
  buffer_load_dwordx4 v[144:147], v12, s[36:39], s79 offen offset:0 nt
  buffer_load_dwordx4 v[148:151], v12, s[36:39], s79 offen offset:2048 nt
  buffer_load_dwordx4 v[152:155], v13, s[36:39], s79 offen offset:0 nt
  buffer_load_dwordx4 v[156:159], v13, s[36:39], s79 offen offset:2048 nt
  s_cmp_ge_u32 s88, 0x10000
  s_cselect_b32 s38, 37748736, 0
  buffer_load_dwordx4 v[160:163], v12, s[36:39], s80 offen offset:0 nt
  buffer_load_dwordx4 v[164:167], v12, s[36:39], s80 offen offset:2048 nt
  buffer_load_dwordx4 v[168:171], v13, s[36:39], s80 offen offset:0 nt
  buffer_load_dwordx4 v[172:175], v13, s[36:39], s80 offen offset:2048 nt
  s_cmp_ge_u32 s89, 0x10000
  s_cselect_b32 s38, 37748736, 0
  buffer_load_dwordx4 v[176:179], v12, s[36:39], s81 offen offset:0 nt
  buffer_load_dwordx4 v[180:183], v12, s[36:39], s81 offen offset:2048 nt
  buffer_load_dwordx4 v[184:187], v13, s[36:39], s81 offen offset:0 nt
  buffer_load_dwordx4 v[188:191], v13, s[36:39], s81 offen offset:2048 nt
  s_nop 3
  s_and_b32 s15, s87, 0xffff
  v_and_b32 v26, s87, v16
  v_cmp_ne_u32 vcc, 0, v26
  v_subrev_u32 v27, s15, v14
  s_nop 0
  v_cndmask_b32 v27, -1, v27, vcc
  v_cmp_lt_i32_e64 s[94:95], 0, v27
  v_cmp_lt_i32_e64 s[96:97], 1, v27
  v_cmp_lt_i32_e64 s[98:99], 2, v27
  v_cmp_lt_i32_e64 s[100:101], 3, v27
  v_cndmask_b32_e64 v72, v18, v72, s[94:95]
  v_cndmask_b32_e64 v73, v18, v73, s[96:97]
  v_cndmask_b32_e64 v74, v18, v74, s[98:99]
  v_cndmask_b32_e64 v75, v18, v75, s[100:101]
  v_max3_f32 v24, v72, v73, v24
  v_max3_f32 v24, v74, v75, v24
  s_branch L_join_1
L_drain4_1:
  s_cmp_ge_u32 s93, 0x10000
  s_cselect_b32 s34, 37748736, 0
  s_mov_b32 s23, s85
  buffer_load_dwordx4 v4, s[32:35], s23 offen nt lds
  s_add_u32 m0, m0, 0x400
  s_add_u32 s23, s23, 0x2000
  buffer_load_dwordx4 v5, s[32:35], s23 offen nt lds
  s_add_u32 m0, m0, 0x400
  s_add_u32 s23, s23, 0x2000
  buffer_load_dwordx4 v6, s[32:35], s23 offen nt lds
  s_add_u32 m0, m0, 0x400
  s_add_u32 s23, s23, 0x2000
  buffer_load_dwordx4 v7, s[32:35], s23 offen nt lds
  s_add_u32 m0, m0, 0x400
  s_cmp_ge_u32 s86, 0x10000
  s_cselect_b32 s38, 37748736, 0
  buffer_load_dwordx4 v[128:131], v12, s[36:39], s78 offen offset:0 nt
  buffer_load_dwordx4 v[132:135], v12, s[36:39], s78 offen offset:2048 nt
  buffer_load_dwordx4 v[136:139], v13, s[36:39], s78 offen offset:0 nt
  buffer_load_dwordx4 v[140:143], v13, s[36:39], s78 offen offset:2048 nt
  s_cmp_ge_u32 s87, 0x10000
  s_cselect_b32 s38, 37748736, 0
  buffer_load_dwordx4 v[144:147], v12, s[36:39], s79 offen offset:0 nt
  buffer_load_dwordx4 v[148:151], v12, s[36:39], s79 offen offset:2048 nt
  buffer_load_dwordx4 v[152:155], v13, s[36:39], s79 offen offset:0 nt
  buffer_load_dwordx4 v[156:159], v13, s[36:39], s79 offen offset:2048 nt
  s_cmp_ge_u32 s88, 0x10000
  s_cselect_b32 s38, 37748736, 0
  buffer_load_dwordx4 v[160:163], v12, s[36:39], s80 offen offset:0 nt
  buffer_load_dwordx4 v[164:167], v12, s[36:39], s80 offen offset:2048 nt
  buffer_load_dwordx4 v[168:171], v13, s[36:39], s80 offen offset:0 nt
  buffer_load_dwordx4 v[172:175], v13, s[36:39], s80 offen offset:2048 nt
  s_cmp_ge_u32 s89, 0x10000
  s_cselect_b32 s38, 37748736, 0
  buffer_load_dwordx4 v[176:179], v12, s[36:39], s81 offen offset:0 nt
  buffer_load_dwordx4 v[180:183], v12, s[36:39], s81 offen offset:2048 nt
  buffer_load_dwordx4 v[184:187], v13, s[36:39], s81 offen offset:0 nt
  buffer_load_dwordx4 v[188:191], v13, s[36:39], s81 offen offset:2048 nt
  s_nop 3
  s_and_b32 s15, s89, 0xffff
  v_and_b32 v26, s89, v16
  v_cmp_ne_u32 vcc, 0, v26
  v_subrev_u32 v27, s15, v14
  s_nop 0
  v_cndmask_b32 v27, -1, v27, vcc
  v_cmp_lt_i32_e64 s[94:95], 0, v27
  v_cmp_lt_i32_e64 s[96:97], 1, v27
  v_cmp_lt_i32_e64 s[98:99], 2, v27
  v_cmp_lt_i32_e64 s[100:101], 3, v27
  v_cndmask_b32_e64 v88, v18, v88, s[94:95]
  v_cndmask_b32_e64 v89, v18, v89, s[96:97]
  v_cndmask_b32_e64 v90, v18, v90, s[98:99]
  v_cndmask_b32_e64 v91, v18, v91, s[100:101]
  v_max3_f32 v24, v88, v89, v24
  v_max3_f32 v24, v90, v91, v24
  s_branch L_join_1
L_drain6_1:
  s_cmp_ge_u32 s87, 0x10000
  s_cselect_b32 s38, 37748736, 0
  buffer_load_dwordx4 v[144:147], v12, s[36:39], s79 offen offset:0 nt
  buffer_load_dwordx4 v[148:151], v12, s[36:39], s79 offen offset:2048 nt
  buffer_load_dwordx4 v[152:155], v13, s[36:39], s79 offen offset:0 nt
  buffer_load_dwordx4 v[156:159], v13, s[36:39], s79 offen offset:2048 nt
  s_cmp_ge_u32 s88, 0x10000
  s_cselect_b32 s38, 37748736, 0
  buffer_load_dwordx4 v[160:163], v12, s[36:39], s80 offen offset:0 nt
  buffer_load_dwordx4 v[164:167], v12, s[36:39], s80 offen offset:2048 nt
  buffer_load_dwordx4 v[168:171], v13, s[36:39], s80 offen offset:0 nt
  buffer_load_dwordx4 v[172:175], v13, s[36:39], s80 offen offset:2048 nt
  s_cmp_ge_u32 s89, 0x10000
  s_cselect_b32 s38, 37748736, 0
  buffer_load_dwordx4 v[176:179], v12, s[36:39], s81 offen offset:0 nt
  buffer_load_dwordx4 v[180:183], v12, s[36:39], s81 offen offset:2048 nt
  buffer_load_dwordx4 v[184:187], v13, s[36:39], s81 offen offset:0 nt
  buffer_load_dwordx4 v[188:191], v13, s[36:39], s81 offen offset:2048 nt
  s_nop 3
  s_and_b32 s15, s91, 0xffff
  v_and_b32 v26, s91, v16
  v_cmp_ne_u32 vcc, 0, v26
  v_subrev_u32 v27, s15, v14
  s_nop 0
  v_cndmask_b32 v27, -1, v27, vcc
  v_cmp_lt_i32_e64 s[94:95], 0, v27
  v_cmp_lt_i32_e64 s[96:97], 1, v27
  v_cmp_lt_i32_e64 s[98:99], 2, v27
  v_cmp_lt_i32_e64 s[100:101], 3, v27
  v_cndmask_b32_e64 v104, v18, v104, s[94:95]
  v_cndmask_b32_e64 v105, v18, v105, s[96:97]
  v_cndmask_b32_e64 v106, v18, v106, s[98:99]
  v_cndmask_b32_e64 v107, v18, v107, s[100:101]
  v_max3_f32 v24, v104, v105, v24
  v_max3_f32 v24, v106, v107, v24
  s_branch L_join_1
L_tail:
  s_waitcnt lgkmcnt(0)
  v_writelane_b32 v21, s64, 16
  v_writelane_b32 v21, s65, 17
  v_writelane_b32 v21, s66, 18
  v_writelane_b32 v21, s67, 19
  v_writelane_b32 v21, s68, 20
  v_writelane_b32 v21, s69, 21
  v_writelane_b32 v21, s70, 22
  v_writelane_b32 v21, s71, 23
  s_barrier
  s_sub_u32 s15, s5, 6
  s_cmp_lt_u32 s15, 16
  s_cbranch_scc1 L_stail
  s_or_b32 s15, s30, s31
  s_cmp_eq_u32 s15, 0
  s_cbranch_scc1 L_fin_exit
  v_mul_u32_u24 v24, 528, v2
  v_lshl_add_u32 v25, v3, 4, v24
  v_mov_b32 v28, 0xff
  s_bfm_b32 s23, s50, 0
  s_mov_b32 s46, 0
L_job:
  s_cmp_eq_u32 s46, 0
  s_cselect_b32 s44, s26, s27
  s_cselect_b32 s25, s30, s31
  s_cmp_eq_u32 s25, 0
  s_cbranch_scc1 L_job_next
  s_cmp_lg_u32 s6, 0
  s_cselect_b32 s45, s44, s3
  s_lshl_b32 s45, s45, 2
  v_add_u32 v26, s45, v2
  v_mul_u32_u24 v26, 520, v26
  v_lshl_add_u32 v27, v3, 4, v26
  ds_read_b64 v[72:73], v26 offset:512
  ds_read2_b64 v[64:67], v27 offset0:0 offset1:1
  ds_read2_b64 v[68:71], v27 offset0:32 offset1:33
  v_add_u32 v26, 32768, v26
  v_add_u32 v27, 32768, v27
  ds_read_b64 v[84:85], v26 offset:512
  ds_read2_b64 v[76:79], v27 offset0:0 offset1:1
  ds_read2_b64 v[80:83], v27 offset0:32 offset1:33
  v_add_u32 v26, 32768, v26
  v_add_u32 v27, 32768, v27
  ds_read_b64 v[96:97], v26 offset:512
  ds_read2_b64 v[88:91], v27 offset0:0 offset1:1
  ds_read2_b64 v[92:95], v27 offset0:32 offset1:33
  v_add_u32 v26, 32768, v26
  v_add_u32 v27, 32768, v27
  ds_read_b64 v[108:109], v26 offset:512
  ds_read2_b64 v[100:103], v27 offset0:0 offset1:1
  ds_read2_b64 v[104:107], v27 offset0:32 offset1:33
  s_add_u32 s15, s44, 16
  v_readlane_b32 s20, v21, s15
  s_nop 0
  s_add_u32 s20, s20, 1
  s_mul_i32 s60, s20, 0x9e3779b1
  s_lshr_b32 s61, s60, 15
  s_xor_b32 s60, s60, s61
  s_lshr_b32 s61, s60, 8
  s_lshr_b32 s62, s60, 16
  s_lshr_b32 s63, s60, 24
  s_lshl_b32 s21, s4, 3
  s_add_u32 s21, s21, s44
  s_lshl_b32 s21, s21, 5
  s_and_b32 s22, s25, s23
  s_bcnt1_i32_b32 s22, s22
  s_add_u32 s21, s21, s22
  s_mul_i32 s21, s21, 2112
  s_add_u32 s21, s21, 4096
  s_waitcnt lgkmcnt(0)
  v_max_f32 v112, v72, v84
  v_max3_f32 v112, v96, v108, v112
  v_bfi_b32 v112, v28, s60, v112
  v_sub_f32 v72, v72, v112
  v_sub_f32 v84, v84, v112
  v_sub_f32 v96, v96, v112
  v_sub_f32 v108, v108, v112
  v_min_f32 v72, 1.0, v72
  v_min_f32 v84, 1.0, v84
  v_min_f32 v96, 1.0, v96
  v_min_f32 v108, 1.0, v108
  v_exp_f32 v72, v72
  v_exp_f32 v84, v84
  v_exp_f32 v96, v96
  v_exp_f32 v108, v108
  s_nop 0
  v_mul_f32 v113, v72, v73
  v_pk_mul_f32 v[116:117], v[72:73], v[64:65] op_sel_hi:[0,1]
  v_pk_mul_f32 v[118:119], v[72:73], v[66:67] op_sel_hi:[0,1]
  v_pk_mul_f32 v[120:121], v[72:73], v[68:69] op_sel_hi:[0,1]
  v_pk_mul_f32 v[122:123], v[72:73], v[70:71] op_sel_hi:[0,1]
  v_fmac_f32 v113, v84, v85
  v_pk_fma_f32 v[116:117], v[84:85], v[76:77], v[116:117] op_sel_hi:[0,1,1]
  v_pk_fma_f32 v[118:119], v[84:85], v[78:79], v[118:119] op_sel_hi:[0,1,1]
  v_pk_fma_f32 v[120:121], v[84:85], v[80:81], v[120:121] op_sel_hi:[0,1,1]
  v_pk_fma_f32 v[122:123], v[84:85], v[82:83], v[122:123] op_sel_hi:[0,1,1]
  v_fmac_f32 v113, v96, v97
  v_pk_fma_f32 v[116:117], v[96:97], v[88:89], v[116:117] op_sel_hi:[0,1,1]
  v_pk_fma_f32 v[118:119], v[96:97], v[90:91], v[118:119] op_sel_hi:[0,1,1]
  v_pk_fma_f32 v[120:121], v[96:97], v[92:93], v[120:121] op_sel_hi:[0,1,1]
  v_pk_fma_f32 v[122:123], v[96:97], v[94:95], v[122:123] op_sel_hi:[0,1,1]
  v_fmac_f32 v113, v108, v109
  v_pk_fma_f32 v[116:117], v[108:109], v[100:101], v[116:117] op_sel_hi:[0,1,1]
  v_pk_fma_f32 v[118:119], v[108:109], v[102:103], v[118:119] op_sel_hi:[0,1,1]
  v_pk_fma_f32 v[120:121], v[108:109], v[104:105], v[120:121] op_sel_hi:[0,1,1]
  v_pk_fma_f32 v[122:123], v[108:109], v[106:107], v[122:123] op_sel_hi:[0,1,1]
  v_bfi_b32 v116, v28, s60, v116
  v_bfi_b32 v117, v28, s61, v117
  v_bfi_b32 v118, v28, s62, v118
  v_bfi_b32 v119, v28, s63, v119
  buffer_store_dwordx4 v[116:119], v25, s[52:55], s21 offen sc1
  v_bfi_b32 v120, v28, s60, v120
  v_bfi_b32 v121, v28, s61, v121
  v_bfi_b32 v122, v28, s62, v122
  v_bfi_b32 v123, v28, s63, v123
  buffer_store_dwordx4 v[120:123], v25, s[52:55], s21 offen offset:256 sc1
  v_bfi_b32 v113, v28, s61, v113
  buffer_store_dwordx2 v[112:113], v24, s[52:55], s21 offen offset:512 sc1
  s_nop 1
L_job_next:
  s_add_u32 s46, s46, 1
  s_cmp_lt_u32 s46, 2
  s_cbranch_scc1 L_job
  s_branch L_fin_exit
L_stail:
  s_lshl_b32 s23, s4, 3
  s_add_u32 s23, s23, s26
  s_and_b32 s15, s26, 3
  s_lshl_b32 s15, s15, 2
  s_add_u32 s15, s15, s3
  s_mul_i32 s15, s15, 520
  v_and_b32 v56, 31, v1
  v_lshlrev_b32 v56, 4, v56
  v_mov_b32 v26, s15
  v_add_u32 v27, s15, v56
  ds_read_b64 v[68:69], v26 offset:512
  ds_read2_b64 v[64:67], v27 offset0:0 offset1:1
  v_add_u32 v27, 32768, v27
  ds_read_b64 v[74:75], v26 offset:33280
  ds_read2_b64 v[70:73], v27 offset0:0 offset1:1
  v_add_u32 v27, 32768, v27
  v_add_u32 v26, 65536, v26
  ds_read_b64 v[80:81], v26 offset:512
  ds_read2_b64 v[76:79], v27 offset0:0 offset1:1
  v_add_u32 v27, 32768, v27
  ds_read_b64 v[86:87], v26 offset:33280
  ds_read2_b64 v[82:85], v27 offset0:0 offset1:1
  s_add_u32 s15, s26, 16
  v_readlane_b32 s20, v21, s15
  s_nop 0
  s_add_u32 s20, s20, 1
  s_mul_i32 s60, s20, 0x9e3779b1
  s_lshr_b32 s61, s60, 15
  s_xor_b32 s60, s60, s61
  s_lshr_b32 s61, s60, 8
  s_lshr_b32 s62, s60, 16
  s_lshr_b32 s63, s60, 24
  s_bcnt1_i32_b32 s65, s30
  s_bfm_b32 s15, s50, 0
  s_and_b32 s15, s15, s30
  s_bcnt1_i32_b32 s66, s15
  s_mul_i32 s67, s23, 67584
  s_mul_i32 s15, s3, 528
  s_add_u32 s67, s67, s15
  s_add_u32 s67, s67, 4096
  s_mul_i32 s21, s66, 2112
  s_add_u32 s21, s21, s67
  v_mov_b32 v59, 0xff
  v_lshrrev_b32 v57, 5, v1
  v_lshl_add_u32 v57, v3, 1, v57
  v_cmp_le_u32 vcc, s66, v57
  v_cmp_gt_u32_e64 s[96:97], 16, v57
  s_waitcnt lgkmcnt(0)
  v_addc_co_u32 v57, vcc, 0, v57, vcc
  s_cmp_eq_u32 s3, 0
  s_cbranch_scc0 L_st_noat
  s_lshl_b32 s15, s23, 2
  v_mov_b32 v28, s15
  v_mov_b32 v29, 1
  s_mov_b64 exec, 1
  global_atomic_add v28, v28, v29, s[28:29] sc0
  s_mov_b64 exec, -1
L_st_noat:
  v_max_f32 v52, v68, v74
  v_cmp_gt_u32_e64 s[94:95], s65, v57
  v_max3_f32 v52, v80, v86, v52
  v_bfi_b32 v52, v59, s60, v52
  s_and_b64 s[94:95], s[94:95], s[96:97]
  v_sub_f32 v68, v68, v52
  v_sub_f32 v74, v74, v52
  v_sub_f32 v80, v80, v52
  v_sub_f32 v86, v86, v52
  v_min_f32 v68, 1.0, v68
  v_min_f32 v74, 1.0, v74
  v_min_f32 v80, 1.0, v80
  v_min_f32 v86, 1.0, v86
  v_exp_f32 v68, v68
  v_exp_f32 v74, v74
  v_exp_f32 v80, v80
  v_exp_f32 v86, v86
  v_cndmask_b32_e64 v57, 0, v57, s[94:95]
  v_mul_f32 v53, v68, v69
  v_pk_mul_f32 v[48:49], v[68:69], v[64:65] op_sel_hi:[0,1]
  v_pk_mul_f32 v[50:51], v[68:69], v[66:67] op_sel_hi:[0,1]
  v_fmac_f32 v53, v74, v75
  v_pk_fma_f32 v[48:49], v[74:75], v[70:71], v[48:49] op_sel_hi:[0,1,1]
  v_pk_fma_f32 v[50:51], v[74:75], v[72:73], v[50:51] op_sel_hi:[0,1,1]
  v_fmac_f32 v53, v80, v81
  v_pk_fma_f32 v[48:49], v[80:81], v[76:77], v[48:49] op_sel_hi:[0,1,1]
  v_pk_fma_f32 v[50:51], v[80:81], v[78:79], v[50:51] op_sel_hi:[0,1,1]
  v_fmac_f32 v53, v86, v87
  v_pk_fma_f32 v[48:49], v[86:87], v[82:83], v[48:49] op_sel_hi:[0,1,1]
  v_pk_fma_f32 v[50:51], v[86:87], v[84:85], v[50:51] op_sel_hi:[0,1,1]
  v_mul_u32_u24 v58, 2112, v57
  v_bfi_b32 v48, v59, s60, v48
  v_bfi_b32 v49, v59, s61, v49
  v_bfi_b32 v50, v59, s62, v50
  v_bfi_b32 v51, v59, s63, v51
  v_bfi_b32 v53, v59, s61, v53
  v_mov_b32 v26, 0
  s_mov_b32 exec_hi, 0
  buffer_store_dwordx4 v[48:51], v56, s[52:55], s21 offen sc1
  s_mov_b32 exec_lo, 1
  buffer_store_dwordx2 v[52:53], v26, s[52:55], s21 offen offset:512 sc1
  s_mov_b64 exec, -1
  s_cmp_eq_u32 s3, 0
  s_cbranch_scc0 L_bar2
  s_mov_b32 s15, 2
  v_mov_b32 v26, 139264
  s_waitcnt vmcnt(2)
  v_readfirstlane_b32 s19, v28
  s_nop 0
  s_add_u32 s19, s19, 1
  s_cmp_eq_u32 s19, s15
  s_cbranch_scc0 L_bar2
  v_mov_b32 v27, 1
  ds_write_b32 v26, v27
L_bar2:
  v_mov_b32 v26, 139264
  s_waitcnt lgkmcnt(0)
  s_barrier
  ds_read_b32 v26, v26
  v_mov_b32 v27, 0xff7fffff
  s_mov_b32 s45, 0x40000
  s_waitcnt lgkmcnt(0)
  v_readfirstlane_b32 s15, v26
  s_nop 0
  s_cmp_eq_u32 s15, 0
  s_cbranch_scc1 L_fin_exit
  s_cmp_gt_u32 s65, 17
  s_cbranch_scc1 L_goslow
  s_mov_b32 s21, 0
  s_mov_b32 s22, s67
L_fl:
  v_add_u32_dpp v114, v58, v56 row_newbcast:0 row_mask:0xf bank_mask:0xf
  buffer_load_dwordx4 v[64:67], v114, s[52:55], s22 offen sc1
  v_add_u32_dpp v115, v58, v56 row_newbcast:1 row_mask:0xf bank_mask:0xf
  buffer_load_dwordx4 v[68:71], v115, s[52:55], s22 offen sc1
  v_add_u32_dpp v114, v58, v56 row_newbcast:2 row_mask:0xf bank_mask:0xf
  buffer_load_dwordx4 v[72:75], v114, s[52:55], s22 offen sc1
  s_cmp_le_u32 s65, 9
  s_cbranch_scc1 L_isd0
  v_add_u32_dpp v115, v58, v56 row_newbcast:4 row_mask:0xf bank_mask:0xf
  buffer_load_dwordx4 v[80:83], v115, s[52:55], s22 offen sc1
  s_cmp_le_u32 s65, 11
  s_cbranch_scc1 L_isd0
  v_add_u32_dpp v114, v58, v56 row_newbcast:5 row_mask:0xf bank_mask:0xf
  buffer_load_dwordx4 v[84:87], v114, s[52:55], s22 offen sc1
  s_cmp_le_u32 s65, 13
  s_cbranch_scc1 L_isd0
  v_add_u32_dpp v115, v58, v56 row_newbcast:6 row_mask:0xf bank_mask:0xf
  buffer_load_dwordx4 v[88:91], v115, s[52:55], s22 offen sc1
  s_cmp_le_u32 s65, 15
  s_cbranch_scc1 L_isd0
  v_add_u32_dpp v114, v58, v56 row_newbcast:7 row_mask:0xf bank_mask:0xf
  buffer_load_dwordx4 v[92:95], v114, s[52:55], s22 offen sc1
L_isd0:
  v_add_u32_dpp v115, v58, v56 row_newbcast:3 row_mask:0xf bank_mask:0xf
  buffer_load_dwordx4 v[76:79], v115, s[52:55], s22 offen sc1
  buffer_load_dwordx2 v[96:97], v58, s[52:55], s22 offen offset:512 sc1
L_fw:
L_fpoll:
  s_waitcnt vmcnt(0)
  v_xor_b32 v102, s60, v96
  v_xor_b32 v103, s61, v97
  v_or_b32 v102, v102, v103
  v_and_b32 v104, 0xff, v102
  v_cmp_ne_u32 vcc, 0, v104
  s_sub_u32 s45, s45, 1
  s_cmp_le_i32 s45, 0
  s_cbranch_scc1 L_fsum
  s_cbranch_vccz L_fsum
  s_or_b32 s15, vcc_lo, vcc_hi
  buffer_load_dwordx2 v[96:97], v58, s[52:55], s67 offen offset:512 sc1
  s_bitcmp1_b32 s15, 0
  s_cbranch_scc0 L_fp0
  v_add_u32_dpp v114, v58, v56 row_newbcast:0 row_mask:0xf bank_mask:0xf
  buffer_load_dwordx4 v[64:67], v114, s[52:55], s67 offen sc1
L_fp0:
  s_bitcmp1_b32 s15, 1
  s_cbranch_scc0 L_fp1
  v_add_u32_dpp v114, v58, v56 row_newbcast:1 row_mask:0xf bank_mask:0xf
  buffer_load_dwordx4 v[68:71], v114, s[52:55], s67 offen sc1
L_fp1:
  s_bitcmp1_b32 s15, 2
  s_cbranch_scc0 L_fp2
  v_add_u32_dpp v114, v58, v56 row_newbcast:2 row_mask:0xf bank_mask:0xf
  buffer_load_dwordx4 v[72:75], v114, s[52:55], s67 offen sc1
L_fp2:
  s_bitcmp1_b32 s15, 3
  s_cbranch_scc0 L_fp3
  v_add_u32_dpp v114, v58, v56 row_newbcast:3 row_mask:0xf bank_mask:0xf
  buffer_load_dwordx4 v[76:79], v114, s[52:55], s67 offen sc1
L_fp3:
  s_bitcmp1_b32 s15, 4
  s_cbranch_scc0 L_fp4
  v_add_u32_dpp v114, v58, v56 row_newbcast:4 row_mask:0xf bank_mask:0xf
  buffer_load_dwordx4 v[80:83], v114, s[52:55], s67 offen sc1
L_fp4:
  s_bitcmp1_b32 s15, 5
  s_cbranch_scc0 L_fp5
  v_add_u32_dpp v114, v58, v56 row_newbcast:5 row_mask:0xf bank_mask:0xf
  buffer_load_dwordx4 v[84:87], v114, s[52:55], s67 offen sc1
L_fp5:
  s_bitcmp1_b32 s15, 6
  s_cbranch_scc0 L_fp6
  v_add_u32_dpp v114, v58, v56 row_newbcast:6 row_mask:0xf bank_mask:0xf
  buffer_load_dwordx4 v[88:91], v114, s[52:55], s67 offen sc1
L_fp6:
  s_bitcmp1_b32 s15, 7
  s_cbranch_scc0 L_fp7
  v_add_u32_dpp v114, v58, v56 row_newbcast:7 row_mask:0xf bank_mask:0xf
  buffer_load_dwordx4 v[92:95], v114, s[52:55], s67 offen sc1
L_fp7:
  s_branch L_fpoll
L_fsum:
  v_cndmask_b32_e64 v96, v27, v96, s[94:95]
  v_cndmask_b32_e64 v97, 0, v97, s[94:95]
  v_max_f32 v104, v96, v52
  v_mov_b32 v106, 0
  v_mov_b32 v107, 0
  v_max_f32_dpp v104, v104, v104 row_ror:8 row_mask:0xf bank_mask:0xf
  v_mov_b32 v108, 0
  v_mov_b32 v109, 0
  v_max_f32_dpp v104, v104, v104 row_ror:4 row_mask:0xf bank_mask:0xf
  v_bitop3_b32 v102, s60, v64, v102 bitop3:0xbe
  v_bitop3_b32 v102, s61, v65, v102 bitop3:0xbe
  v_max_f32_dpp v104, v104, v104 row_ror:2 row_mask:0xf bank_mask:0xf
  v_bitop3_b32 v102, s62, v66, v102 bitop3:0xbe
  v_bitop3_b32 v102, s63, v67, v102 bitop3:0xbe
  v_max_f32_dpp v104, v104, v104 row_ror:1 row_mask:0xf bank_mask:0xf
  s_nop 0
  v_mov_b32 v103, v104
  s_nop 1
  v_permlane32_swap_b32 v104, v103
  s_nop 0
  v_max_f32 v104, v104, v103
  v_sub_f32 v98, v96, v104
  v_sub_f32 v114, v52, v104
  v_exp_f32 v98, v98
  v_exp_f32 v114, v114
  s_nop 0
  v_mul_f32 v99, v98, v97
  s_nop 0
  v_mov_b32_dpp v100, v98 row_newbcast:0 row_mask:0xf bank_mask:0xf
  v_pk_fma_f32 v[106:107], v[100:101], v[64:65], v[106:107] op_sel_hi:[0,1,1]
  v_pk_fma_f32 v[108:109], v[100:101], v[66:67], v[108:109] op_sel_hi:[0,1,1]
  s_nop 0
  v_add_f32_dpp v99, v99, v99 row_ror:8 row_mask:0xf bank_mask:0xf
  v_mov_b32_dpp v100, v98 row_newbcast:1 row_mask:0xf bank_mask:0xf
  v_bitop3_b32 v102, s60, v68, v102 bitop3:0xbe
  v_bitop3_b32 v102, s61, v69, v102 bitop3:0xbe
  v_pk_fma_f32 v[106:107], v[100:101], v[68:69], v[106:107] op_sel_hi:[0,1,1]
  v_bitop3_b32 v102, s62, v70, v102 bitop3:0xbe
  v_bitop3_b32 v102, s63, v71, v102 bitop3:0xbe
  v_pk_fma_f32 v[108:109], v[100:101], v[70:71], v[108:109] op_sel_hi:[0,1,1]
  v_add_f32_dpp v99, v99, v99 row_ror:4 row_mask:0xf bank_mask:0xf
  v_mov_b32_dpp v100, v98 row_newbcast:2 row_mask:0xf bank_mask:0xf
  v_bitop3_b32 v102, s60, v72, v102 bitop3:0xbe
  v_bitop3_b32 v102, s61, v73, v102 bitop3:0xbe
  v_pk_fma_f32 v[106:107], v[100:101], v[72:73], v[106:107] op_sel_hi:[0,1,1]
  v_bitop3_b32 v102, s62, v74, v102 bitop3:0xbe
  v_bitop3_b32 v102, s63, v75, v102 bitop3:0xbe
  v_pk_fma_f32 v[108:109], v[100:101], v[74:75], v[108:109] op_sel_hi:[0,1,1]
  v_add_f32_dpp v99, v99, v99 row_ror:2 row_mask:0xf bank_mask:0xf
  v_mov_b32_dpp v100, v98 row_newbcast:3 row_mask:0xf bank_mask:0xf
  v_bitop3_b32 v102, s60, v76, v102 bitop3:0xbe
  v_bitop3_b32 v102, s61, v77, v102 bitop3:0xbe
  v_pk_fma_f32 v[106:107], v[100:101], v[76:77], v[106:107] op_sel_hi:[0,1,1]
  v_bitop3_b32 v102, s62, v78, v102 bitop3:0xbe
  v_bitop3_b32 v102, s63, v79, v102 bitop3:0xbe
  v_pk_fma_f32 v[108:109], v[100:101], v[78:79], v[108:109] op_sel_hi:[0,1,1]
  v_add_f32_dpp v99, v99, v99 row_ror:1 row_mask:0xf bank_mask:0xf
  s_cmp_le_u32 s65, 9
  s_cbranch_scc1 L_facc
  v_mov_b32_dpp v100, v98 row_newbcast:4 row_mask:0xf bank_mask:0xf
  v_bitop3_b32 v102, s60, v80, v102 bitop3:0xbe
  v_bitop3_b32 v102, s61, v81, v102 bitop3:0xbe
  v_pk_fma_f32 v[106:107], v[100:101], v[80:81], v[106:107] op_sel_hi:[0,1,1]
  v_bitop3_b32 v102, s62, v82, v102 bitop3:0xbe
  v_bitop3_b32 v102, s63, v83, v102 bitop3:0xbe
  v_pk_fma_f32 v[108:109], v[100:101], v[82:83], v[108:109] op_sel_hi:[0,1,1]
  s_cmp_le_u32 s65, 11
  s_cbranch_scc1 L_facc
  v_mov_b32_dpp v100, v98 row_newbcast:5 row_mask:0xf bank_mask:0xf
  v_bitop3_b32 v102, s60, v84, v102 bitop3:0xbe
  v_bitop3_b32 v102, s61, v85, v102 bitop3:0xbe
  v_pk_fma_f32 v[106:107], v[100:101], v[84:85], v[106:107] op_sel_hi:[0,1,1]
  v_bitop3_b32 v102, s62, v86, v102 bitop3:0xbe
  v_bitop3_b32 v102, s63, v87, v102 bitop3:0xbe
  v_pk_fma_f32 v[108:109], v[100:101], v[86:87], v[108:109] op_sel_hi:[0,1,1]
  s_cmp_le_u32 s65, 13
  s_cbranch_scc1 L_facc
  v_mov_b32_dpp v100, v98 row_newbcast:6 row_mask:0xf bank_mask:0xf
  v_bitop3_b32 v102, s60, v88, v102 bitop3:0xbe
  v_bitop3_b32 v102, s61, v89, v102 bitop3:0xbe
  v_pk_fma_f32 v[106:107], v[100:101], v[88:89], v[106:107] op_sel_hi:[0,1,1]
  v_bitop3_b32 v102, s62, v90, v102 bitop3:0xbe
  v_bitop3_b32 v102, s63, v91, v102 bitop3:0xbe
  v_pk_fma_f32 v[108:109], v[100:101], v[90:91], v[108:109] op_sel_hi:[0,1,1]
  s_cmp_le_u32 s65, 15
  s_cbranch_scc1 L_facc
  v_mov_b32_dpp v100, v98 row_newbcast:7 row_mask:0xf bank_mask:0xf
  v_bitop3_b32 v102, s60, v92, v102 bitop3:0xbe
  v_bitop3_b32 v102, s61, v93, v102 bitop3:0xbe
  v_pk_fma_f32 v[106:107], v[100:101], v[92:93], v[106:107] op_sel_hi:[0,1,1]
  v_bitop3_b32 v102, s62, v94, v102 bitop3:0xbe
  v_bitop3_b32 v102, s63, v95, v102 bitop3:0xbe
  v_pk_fma_f32 v[108:109], v[100:101], v[94:95], v[108:109] op_sel_hi:[0,1,1]
L_facc:
  v_and_b32 v102, 0xff, v102
  v_cmp_ne_u32 vcc, 0, v102
  v_mov_b32 v103, v99
  v_mov_b32 v110, v106
  v_mov_b32 v111, v107
  v_mov_b32 v112, v108
  v_mov_b32 v113, v109
  s_sub_u32 s45, s45, 1
  s_cmp_le_i32 s45, 0
  s_cbranch_scc1 L_fg
  s_cbranch_vccz L_fg
  s_branch L_fl
L_fg:
  v_permlane32_swap_b32 v99, v103
  v_permlane32_swap_b32 v106, v110
  v_permlane32_swap_b32 v107, v111
  v_permlane32_swap_b32 v108, v112
  v_permlane32_swap_b32 v109, v113
  s_lshl_b32 s15, s26, 13
  s_lshl_b32 s19, s4, 10
  v_add_f32 v99, v99, v103
  s_add_u32 s15, s15, s19
  s_lshl_b32 s19, s3, 8
  v_fmac_f32 v99, v114, v53
  v_pk_add_f32 v[106:107], v[106:107], v[110:111]
  v_pk_add_f32 v[108:109], v[108:109], v[112:113]
  v_rcp_f32 v100, v99
  v_pk_fma_f32 v[106:107], v[114:115], v[48:49], v[106:107] op_sel_hi:[0,1,1]
  v_pk_fma_f32 v[108:109], v[114:115], v[50:51], v[108:109] op_sel_hi:[0,1,1]
  s_add_u32 s15, s15, s19
  v_lshrrev_b32 v104, 1, v56
  v_pk_mul_f32 v[106:107], v[100:101], v[106:107] op_sel_hi:[0,1]
  v_pk_mul_f32 v[108:109], v[100:101], v[108:109] op_sel_hi:[0,1]
  v_cvt_pk_bf16_f32 v106, v106, v107
  v_cvt_pk_bf16_f32 v107, v108, v109
  s_mov_b32 exec_hi, 0
  buffer_store_dwordx2 v[106:107], v104, s[56:59], s15 offen sc1
  s_mov_b64 exec, -1
  s_cmp_eq_u32 s3, 0
  s_cbranch_scc0 L_fin_more
  s_lshl_b32 s15, s23, 2
  v_mov_b32 v103, 0
  v_mov_b32 v104, s20
  s_mov_b64 exec, 1
  buffer_store_dword v104, v103, s[52:55], s15 offen sc1
  s_mov_b64 exec, -1
L_fin_more:
  s_branch L_fin_exit
L_goslow:
  s_mov_b32 s44, s26
  s_mov_b32 s19, s65
  v_lshlrev_b32 v24, 3, v1
  v_and_b32 v26, 1, v1
  v_lshlrev_b32 v29, 4, v26
L_slow:
  s_add_u32 s15, s44, 16
  v_readlane_b32 s20, v21, s15
  s_nop 0
  s_add_u32 s20, s20, 1
  s_mul_i32 s60, s20, 0x9e3779b1
  s_lshr_b32 s61, s60, 15
  s_xor_b32 s60, s60, s61
  s_lshr_b32 s61, s60, 8
  s_lshr_b32 s62, s60, 16
  s_lshr_b32 s63, s60, 24
  s_mov_b32 s47, s20
  s_lshl_b32 s21, s4, 3
  s_add_u32 s21, s21, s44
  s_mul_i32 s21, s21, 67584
  s_mul_i32 s22, s3, 528
  s_add_u32 s21, s21, s22
  s_add_u32 s21, s21, 4096+0
  s_sub_u32 s15, s19, 1
  v_min_u32 v55, s15, v3
  v_mul_u32_u24 v55, 2112, v55
  v_add_u32 v53, 16, v3
  v_min_u32 v53, s15, v53
  v_mul_u32_u24 v54, 2112, v53
  v_mov_b32 v50, s60
  v_lshrrev_b32 v50, v29, v50
  v_lshrrev_b32 v51, 8, v50
  s_mov_b32 s45, 0x40000
L_sl_load:
  s_mov_b32 s22, s21
  buffer_load_dwordx2 v[40:41], v55, s[52:55], s22 offen offset:512 sc1
  s_cmp_le_u32 s19, 16
  s_cbranch_scc1 L_sl_nomb
  buffer_load_dwordx2 v[42:43], v54, s[52:55], s22 offen offset:512 sc1
L_sl_nomb:
  buffer_load_dwordx2 v[64:65], v24, s[52:55], s22 offen sc1
  s_add_u32 s22, s22, 2112
  s_cmp_le_u32 s19, 1
  s_cbranch_scc1 L_sl_issued
  buffer_load_dwordx2 v[66:67], v24, s[52:55], s22 offen sc1
  s_add_u32 s22, s22, 2112
  s_cmp_le_u32 s19, 2
  s_cbranch_scc1 L_sl_issued
  buffer_load_dwordx2 v[68:69], v24, s[52:55], s22 offen sc1
  s_add_u32 s22, s22, 2112
  s_cmp_le_u32 s19, 3
  s_cbranch_scc1 L_sl_issued
  buffer_load_dwordx2 v[70:71], v24, s[52:55], s22 offen sc1
  s_add_u32 s22, s22, 2112
  s_cmp_le_u32 s19, 4
  s_cbranch_scc1 L_sl_issued
  buffer_load_dwordx2 v[72:73], v24, s[52:55], s22 offen sc1
  s_add_u32 s22, s22, 2112
  s_cmp_le_u32 s19, 5
  s_cbranch_scc1 L_sl_issued
  buffer_load_dwordx2 v[74:75], v24, s[52:55], s22 offen sc1
  s_add_u32 s22, s22, 2112
  s_cmp_le_u32 s19, 6
  s_cbranch_scc1 L_sl_issued
  buffer_load_dwordx2 v[76:77], v24, s[52:55], s22 offen sc1
  s_add_u32 s22, s22, 2112
  s_cmp_le_u32 s19, 7
  s_cbranch_scc1 L_sl_issued
  buffer_load_dwordx2 v[78:79], v24, s[52:55], s22 offen sc1
  s_add_u32 s22, s22, 2112
  s_cmp_le_u32 s19, 8
  s_cbranch_scc1 L_sl_issued
  buffer_load_dwordx2 v[80:81], v24, s[52:55], s22 offen sc1
  s_add_u32 s22, s22, 2112
  s_cmp_le_u32 s19, 9
  s_cbranch_scc1 L_sl_issued
  buffer_load_dwordx2 v[82:83], v24, s[52:55], s22 offen sc1
  s_add_u32 s22, s22, 2112
  s_cmp_le_u32 s19, 10
  s_cbranch_scc1 L_sl_issued
  buffer_load_dwordx2 v[84:85], v24, s[52:55], s22 offen sc1
  s_add_u32 s22, s22, 2112
  s_cmp_le_u32 s19, 11
  s_cbranch_scc1 L_sl_issued
  buffer_load_dwordx2 v[86:87], v24, s[52:55], s22 offen sc1
  s_add_u32 s22, s22, 2112
  s_cmp_le_u32 s19, 12
  s_cbranch_scc1 L_sl_issued
  buffer_load_dwordx2 v[88:89], v24, s[52:55], s22 offen sc1
  s_add_u32 s22, s22, 2112
  s_cmp_le_u32 s19, 13
  s_cbranch_scc1 L_sl_issued
  buffer_load_dwordx2 v[90:91], v24, s[52:55], s22 offen sc1
  s_add_u32 s22, s22, 2112
  s_cmp_le_u32 s19, 14
  s_cbranch_scc1 L_sl_issued
  buffer_load_dwordx2 v[92:93], v24, s[52:55], s22 offen sc1
  s_add_u32 s22, s22, 2112
  s_cmp_le_u32 s19, 15
  s_cbranch_scc1 L_sl_issued
  buffer_load_dwordx2 v[94:95], v24, s[52:55], s22 offen sc1
  s_add_u32 s22, s22, 2112
  s_cmp_le_u32 s19, 16
  s_cbranch_scc1 L_sl_issued
  buffer_load_dwordx2 v[96:97], v24, s[52:55], s22 offen sc1
  s_add_u32 s22, s22, 2112
  s_cmp_le_u32 s19, 17
  s_cbranch_scc1 L_sl_issued
  buffer_load_dwordx2 v[98:99], v24, s[52:55], s22 offen sc1
  s_add_u32 s22, s22, 2112
  s_cmp_le_u32 s19, 18
  s_cbranch_scc1 L_sl_issued
  buffer_load_dwordx2 v[100:101], v24, s[52:55], s22 offen sc1
  s_add_u32 s22, s22, 2112
  s_cmp_le_u32 s19, 19
  s_cbranch_scc1 L_sl_issued
  buffer_load_dwordx2 v[102:103], v24, s[52:55], s22 offen sc1
  s_add_u32 s22, s22, 2112
  s_cmp_le_u32 s19, 20
  s_cbranch_scc1 L_sl_issued
  buffer_load_dwordx2 v[104:105], v24, s[52:55], s22 offen sc1
  s_add_u32 s22, s22, 2112
  s_cmp_le_u32 s19, 21
  s_cbranch_scc1 L_sl_issued
  buffer_load_dwordx2 v[106:107], v24, s[52:55], s22 offen sc1
  s_add_u32 s22, s22, 2112
  s_cmp_le_u32 s19, 22
  s_cbranch_scc1 L_sl_issued
  buffer_load_dwordx2 v[108:109], v24, s[52:55], s22 offen sc1
  s_add_u32 s22, s22, 2112
  s_cmp_le_u32 s19, 23
  s_cbranch_scc1 L_sl_issued
  buffer_load_dwordx2 v[110:111], v24, s[52:55], s22 offen sc1
  s_add_u32 s22, s22, 2112
  s_cmp_le_u32 s19, 24
  s_cbranch_scc1 L_sl_issued
  buffer_load_dwordx2 v[112:113], v24, s[52:55], s22 offen sc1
  s_add_u32 s22, s22, 2112
  s_cmp_le_u32 s19, 25
  s_cbranch_scc1 L_sl_issued
  buffer_load_dwordx2 v[114:115], v24, s[52:55], s22 offen sc1
  s_add_u32 s22, s22, 2112
  s_cmp_le_u32 s19, 26
  s_cbranch_scc1 L_sl_issued
  buffer_load_dwordx2 v[116:117], v24, s[52:55], s22 offen sc1
  s_add_u32 s22, s22, 2112
  s_cmp_le_u32 s19, 27
  s_cbranch_scc1 L_sl_issued
  buffer_load_dwordx2 v[118:119], v24, s[52:55], s22 offen sc1
  s_add_u32 s22, s22, 2112
  s_cmp_le_u32 s19, 28
  s_cbranch_scc1 L_sl_issued
  buffer_load_dwordx2 v[120:121], v24, s[52:55], s22 offen sc1
  s_add_u32 s22, s22, 2112
  s_cmp_le_u32 s19, 29
  s_cbranch_scc1 L_sl_issued
  buffer_load_dwordx2 v[122:123], v24, s[52:55], s22 offen sc1
  s_add_u32 s22, s22, 2112
  s_cmp_le_u32 s19, 30
  s_cbranch_scc1 L_sl_issued
  buffer_load_dwordx2 v[124:125], v24, s[52:55], s22 offen sc1
  s_add_u32 s22, s22, 2112
  s_cmp_le_u32 s19, 31
  s_cbranch_scc1 L_sl_issued
  buffer_load_dwordx2 v[126:127], v24, s[52:55], s22 offen sc1
L_sl_issued:
  v_add_u32 v26, 16, v3
  v_cmp_gt_u32 vcc, s19, v3
  v_cmp_gt_u32_e64 s[94:95], s19, v26
  v_mov_b32 v27, 0xff7fffff
  s_waitcnt vmcnt(0)
  v_xor_b32 v52, s60, v40
  v_xor_b32 v53, s61, v41
  v_or_b32 v52, v52, v53
  s_cmp_le_u32 s19, 16
  s_cbranch_scc1 L_sl_nomb2
  v_xor_b32 v26, s60, v42
  v_xor_b32 v53, s61, v43
  v_or3_b32 v52, v52, v26, v53
L_sl_nomb2:
  v_cndmask_b32 v40, v27, v40, vcc
  v_cndmask_b32 v41, 0, v41, vcc
  v_cndmask_b32_e64 v42, v27, v42, s[94:95]
  v_cndmask_b32_e64 v43, 0, v43, s[94:95]
  v_max_f32 v26, v40, v42
  s_nop 1
  v_max_f32_dpp v26, v26, v26 row_ror:8 row_mask:0xf bank_mask:0xf
  s_nop 1
  v_max_f32_dpp v26, v26, v26 row_ror:4 row_mask:0xf bank_mask:0xf
  s_nop 1
  v_max_f32_dpp v26, v26, v26 row_ror:2 row_mask:0xf bank_mask:0xf
  s_nop 1
  v_max_f32_dpp v26, v26, v26 row_ror:1 row_mask:0xf bank_mask:0xf
  v_sub_f32 v44, v40, v26
  v_sub_f32 v45, v42, v26
  v_exp_f32 v44, v44
  v_exp_f32 v45, v45
  v_mov_b32 v32, 0
  v_mov_b32 v33, 0
  v_mul_f32 v46, v44, v41
  v_fmac_f32 v46, v45, v43
  v_mov_b32_dpp v48, v44 row_newbcast:0 row_mask:0xf bank_mask:0xf
  v_xor_b32 v26, v50, v64
  v_xor_b32 v53, v51, v65
  v_pk_fma_f32 v[32:33], v[48:49], v[64:65], v[32:33] op_sel_hi:[0,1,1]
  v_or3_b32 v52, v52, v26, v53
  s_cmp_le_u32 s19, 1
  s_cbranch_scc1 L_sl_acc
  v_mov_b32_dpp v48, v44 row_newbcast:1 row_mask:0xf bank_mask:0xf
  v_xor_b32 v26, v50, v66
  v_xor_b32 v53, v51, v67
  v_pk_fma_f32 v[32:33], v[48:49], v[66:67], v[32:33] op_sel_hi:[0,1,1]
  v_or3_b32 v52, v52, v26, v53
  s_cmp_le_u32 s19, 2
  s_cbranch_scc1 L_sl_acc
  v_mov_b32_dpp v48, v44 row_newbcast:2 row_mask:0xf bank_mask:0xf
  v_xor_b32 v26, v50, v68
  v_xor_b32 v53, v51, v69
  v_pk_fma_f32 v[32:33], v[48:49], v[68:69], v[32:33] op_sel_hi:[0,1,1]
  v_or3_b32 v52, v52, v26, v53
  s_cmp_le_u32 s19, 3
  s_cbranch_scc1 L_sl_acc
  v_mov_b32_dpp v48, v44 row_newbcast:3 row_mask:0xf bank_mask:0xf
  v_xor_b32 v26, v50, v70
  v_xor_b32 v53, v51, v71
  v_pk_fma_f32 v[32:33], v[48:49], v[70:71], v[32:33] op_sel_hi:[0,1,1]
  v_or3_b32 v52, v52, v26, v53
  s_cmp_le_u32 s19, 4
  s_cbranch_scc1 L_sl_acc
  v_mov_b32_dpp v48, v44 row_newbcast:4 row_mask:0xf bank_mask:0xf
  v_xor_b32 v26, v50, v72
  v_xor_b32 v53, v51, v73
  v_pk_fma_f32 v[32:33], v[48:49], v[72:73], v[32:33] op_sel_hi:[0,1,1]
  v_or3_b32 v52, v52, v26, v53
  s_cmp_le_u32 s19, 5
  s_cbranch_scc1 L_sl_acc
  v_mov_b32_dpp v48, v44 row_newbcast:5 row_mask:0xf bank_mask:0xf
  v_xor_b32 v26, v50, v74
  v_xor_b32 v53, v51, v75
  v_pk_fma_f32 v[32:33], v[48:49], v[74:75], v[32:33] op_sel_hi:[0,1,1]
  v_or3_b32 v52, v52, v26, v53
  s_cmp_le_u32 s19, 6
  s_cbranch_scc1 L_sl_acc
  v_mov_b32_dpp v48, v44 row_newbcast:6 row_mask:0xf bank_mask:0xf
  v_xor_b32 v26, v50, v76
  v_xor_b32 v53, v51, v77
  v_pk_fma_f32 v[32:33], v[48:49], v[76:77], v[32:33] op_sel_hi:[0,1,1]
  v_or3_b32 v52, v52, v26, v53
  s_cmp_le_u32 s19, 7
  s_cbranch_scc1 L_sl_acc
  v_mov_b32_dpp v48, v44 row_newbcast:7 row_mask:0xf bank_mask:0xf
  v_xor_b32 v26, v50, v78
  v_xor_b32 v53, v51, v79
  v_pk_fma_f32 v[32:33], v[48:49], v[78:79], v[32:33] op_sel_hi:[0,1,1]
  v_or3_b32 v52, v52, v26, v53
  s_cmp_le_u32 s19, 8
  s_cbranch_scc1 L_sl_acc
  v_mov_b32_dpp v48, v44 row_newbcast:8 row_mask:0xf bank_mask:0xf
  v_xor_b32 v26, v50, v80
  v_xor_b32 v53, v51, v81
  v_pk_fma_f32 v[32:33], v[48:49], v[80:81], v[32:33] op_sel_hi:[0,1,1]
  v_or3_b32 v52, v52, v26, v53
  s_cmp_le_u32 s19, 9
  s_cbranch_scc1 L_sl_acc
  v_mov_b32_dpp v48, v44 row_newbcast:9 row_mask:0xf bank_mask:0xf
  v_xor_b32 v26, v50, v82
  v_xor_b32 v53, v51, v83
  v_pk_fma_f32 v[32:33], v[48:49], v[82:83], v[32:33] op_sel_hi:[0,1,1]
  v_or3_b32 v52, v52, v26, v53
  s_cmp_le_u32 s19, 10
  s_cbranch_scc1 L_sl_acc
  v_mov_b32_dpp v48, v44 row_newbcast:10 row_mask:0xf bank_mask:0xf
  v_xor_b32 v26, v50, v84
  v_xor_b32 v53, v51, v85
  v_pk_fma_f32 v[32:33], v[48:49], v[84:85], v[32:33] op_sel_hi:[0,1,1]
  v_or3_b32 v52, v52, v26, v53
  s_cmp_le_u32 s19, 11
  s_cbranch_scc1 L_sl_acc
  v_mov_b32_dpp v48, v44 row_newbcast:11 row_mask:0xf bank_mask:0xf
  v_xor_b32 v26, v50, v86
  v_xor_b32 v53, v51, v87
  v_pk_fma_f32 v[32:33], v[48:49], v[86:87], v[32:33] op_sel_hi:[0,1,1]
  v_or3_b32 v52, v52, v26, v53
  s_cmp_le_u32 s19, 12
  s_cbranch_scc1 L_sl_acc
  v_mov_b32_dpp v48, v44 row_newbcast:12 row_mask:0xf bank_mask:0xf
  v_xor_b32 v26, v50, v88
  v_xor_b32 v53, v51, v89
  v_pk_fma_f32 v[32:33], v[48:49], v[88:89], v[32:33] op_sel_hi:[0,1,1]
  v_or3_b32 v52, v52, v26, v53
  s_cmp_le_u32 s19, 13
  s_cbranch_scc1 L_sl_acc
  v_mov_b32_dpp v48, v44 row_newbcast:13 row_mask:0xf bank_mask:0xf
  v_xor_b32 v26, v50, v90
  v_xor_b32 v53, v51, v91
  v_pk_fma_f32 v[32:33], v[48:49], v[90:91], v[32:33] op_sel_hi:[0,1,1]
  v_or3_b32 v52, v52, v26, v53
  s_cmp_le_u32 s19, 14
  s_cbranch_scc1 L_sl_acc
  v_mov_b32_dpp v48, v44 row_newbcast:14 row_mask:0xf bank_mask:0xf
  v_xor_b32 v26, v50, v92
  v_xor_b32 v53, v51, v93
  v_pk_fma_f32 v[32:33], v[48:49], v[92:93], v[32:33] op_sel_hi:[0,1,1]
  v_or3_b32 v52, v52, v26, v53
  s_cmp_le_u32 s19, 15
  s_cbranch_scc1 L_sl_acc
  v_mov_b32_dpp v48, v44 row_newbcast:15 row_mask:0xf bank_mask:0xf
  v_xor_b32 v26, v50, v94
  v_xor_b32 v53, v51, v95
  v_pk_fma_f32 v[32:33], v[48:49], v[94:95], v[32:33] op_sel_hi:[0,1,1]
  v_or3_b32 v52, v52, v26, v53
  s_cmp_le_u32 s19, 16
  s_cbranch_scc1 L_sl_acc
  v_mov_b32_dpp v48, v45 row_newbcast:0 row_mask:0xf bank_mask:0xf
  v_xor_b32 v26, v50, v96
  v_xor_b32 v53, v51, v97
  v_pk_fma_f32 v[32:33], v[48:49], v[96:97], v[32:33] op_sel_hi:[0,1,1]
  v_or3_b32 v52, v52, v26, v53
  s_cmp_le_u32 s19, 17
  s_cbranch_scc1 L_sl_acc
  v_mov_b32_dpp v48, v45 row_newbcast:1 row_mask:0xf bank_mask:0xf
  v_xor_b32 v26, v50, v98
  v_xor_b32 v53, v51, v99
  v_pk_fma_f32 v[32:33], v[48:49], v[98:99], v[32:33] op_sel_hi:[0,1,1]
  v_or3_b32 v52, v52, v26, v53
  s_cmp_le_u32 s19, 18
  s_cbranch_scc1 L_sl_acc
  v_mov_b32_dpp v48, v45 row_newbcast:2 row_mask:0xf bank_mask:0xf
  v_xor_b32 v26, v50, v100
  v_xor_b32 v53, v51, v101
  v_pk_fma_f32 v[32:33], v[48:49], v[100:101], v[32:33] op_sel_hi:[0,1,1]
  v_or3_b32 v52, v52, v26, v53
  s_cmp_le_u32 s19, 19
  s_cbranch_scc1 L_sl_acc
  v_mov_b32_dpp v48, v45 row_newbcast:3 row_mask:0xf bank_mask:0xf
  v_xor_b32 v26, v50, v102
  v_xor_b32 v53, v51, v103
  v_pk_fma_f32 v[32:33], v[48:49], v[102:103], v[32:33] op_sel_hi:[0,1,1]
  v_or3_b32 v52, v52, v26, v53
  s_cmp_le_u32 s19, 20
  s_cbranch_scc1 L_sl_acc
  v_mov_b32_dpp v48, v45 row_newbcast:4 row_mask:0xf bank_mask:0xf
  v_xor_b32 v26, v50, v104
  v_xor_b32 v53, v51, v105
  v_pk_fma_f32 v[32:33], v[48:49], v[104:105], v[32:33] op_sel_hi:[0,1,1]
  v_or3_b32 v52, v52, v26, v53
  s_cmp_le_u32 s19, 21
  s_cbranch_scc1 L_sl_acc
  v_mov_b32_dpp v48, v45 row_newbcast:5 row_mask:0xf bank_mask:0xf
  v_xor_b32 v26, v50, v106
  v_xor_b32 v53, v51, v107
  v_pk_fma_f32 v[32:33], v[48:49], v[106:107], v[32:33] op_sel_hi:[0,1,1]
  v_or3_b32 v52, v52, v26, v53
  s_cmp_le_u32 s19, 22
  s_cbranch_scc1 L_sl_acc
  v_mov_b32_dpp v48, v45 row_newbcast:6 row_mask:0xf bank_mask:0xf
  v_xor_b32 v26, v50, v108
  v_xor_b32 v53, v51, v109
  v_pk_fma_f32 v[32:33], v[48:49], v[108:109], v[32:33] op_sel_hi:[0,1,1]
  v_or3_b32 v52, v52, v26, v53
  s_cmp_le_u32 s19, 23
  s_cbranch_scc1 L_sl_acc
  v_mov_b32_dpp v48, v45 row_newbcast:7 row_mask:0xf bank_mask:0xf
  v_xor_b32 v26, v50, v110
  v_xor_b32 v53, v51, v111
  v_pk_fma_f32 v[32:33], v[48:49], v[110:111], v[32:33] op_sel_hi:[0,1,1]
  v_or3_b32 v52, v52, v26, v53
  s_cmp_le_u32 s19, 24
  s_cbranch_scc1 L_sl_acc
  v_mov_b32_dpp v48, v45 row_newbcast:8 row_mask:0xf bank_mask:0xf
  v_xor_b32 v26, v50, v112
  v_xor_b32 v53, v51, v113
  v_pk_fma_f32 v[32:33], v[48:49], v[112:113], v[32:33] op_sel_hi:[0,1,1]
  v_or3_b32 v52, v52, v26, v53
  s_cmp_le_u32 s19, 25
  s_cbranch_scc1 L_sl_acc
  v_mov_b32_dpp v48, v45 row_newbcast:9 row_mask:0xf bank_mask:0xf
  v_xor_b32 v26, v50, v114
  v_xor_b32 v53, v51, v115
  v_pk_fma_f32 v[32:33], v[48:49], v[114:115], v[32:33] op_sel_hi:[0,1,1]
  v_or3_b32 v52, v52, v26, v53
  s_cmp_le_u32 s19, 26
  s_cbranch_scc1 L_sl_acc
  v_mov_b32_dpp v48, v45 row_newbcast:10 row_mask:0xf bank_mask:0xf
  v_xor_b32 v26, v50, v116
  v_xor_b32 v53, v51, v117
  v_pk_fma_f32 v[32:33], v[48:49], v[116:117], v[32:33] op_sel_hi:[0,1,1]
  v_or3_b32 v52, v52, v26, v53
  s_cmp_le_u32 s19, 27
  s_cbranch_scc1 L_sl_acc
  v_mov_b32_dpp v48, v45 row_newbcast:11 row_mask:0xf bank_mask:0xf
  v_xor_b32 v26, v50, v118
  v_xor_b32 v53, v51, v119
  v_pk_fma_f32 v[32:33], v[48:49], v[118:119], v[32:33] op_sel_hi:[0,1,1]
  v_or3_b32 v52, v52, v26, v53
  s_cmp_le_u32 s19, 28
  s_cbranch_scc1 L_sl_acc
  v_mov_b32_dpp v48, v45 row_newbcast:12 row_mask:0xf bank_mask:0xf
  v_xor_b32 v26, v50, v120
  v_xor_b32 v53, v51, v121
  v_pk_fma_f32 v[32:33], v[48:49], v[120:121], v[32:33] op_sel_hi:[0,1,1]
  v_or3_b32 v52, v52, v26, v53
  s_cmp_le_u32 s19, 29
  s_cbranch_scc1 L_sl_acc
  v_mov_b32_dpp v48, v45 row_newbcast:13 row_mask:0xf bank_mask:0xf
  v_xor_b32 v26, v50, v122
  v_xor_b32 v53, v51, v123
  v_pk_fma_f32 v[32:33], v[48:49], v[122:123], v[32:33] op_sel_hi:[0,1,1]
  v_or3_b32 v52, v52, v26, v53
  s_cmp_le_u32 s19, 30
  s_cbranch_scc1 L_sl_acc
  v_mov_b32_dpp v48, v45 row_newbcast:14 row_mask:0xf bank_mask:0xf
  v_xor_b32 v26, v50, v124
  v_xor_b32 v53, v51, v125
  v_pk_fma_f32 v[32:33], v[48:49], v[124:125], v[32:33] op_sel_hi:[0,1,1]
  v_or3_b32 v52, v52, v26, v53
  s_cmp_le_u32 s19, 31
  s_cbranch_scc1 L_sl_acc
  v_mov_b32_dpp v48, v45 row_newbcast:15 row_mask:0xf bank_mask:0xf
  v_xor_b32 v26, v50, v126
  v_xor_b32 v53, v51, v127
  v_pk_fma_f32 v[32:33], v[48:49], v[126:127], v[32:33] op_sel_hi:[0,1,1]
  v_or3_b32 v52, v52, v26, v53
L_sl_acc:
  v_and_b32 v52, 0xff, v52
  v_cmp_ne_u32 vcc, 0, v52
  v_add_f32_dpp v46, v46, v46 row_ror:8 row_mask:0xf bank_mask:0xf
  s_sub_u32 s45, s45, 1
  s_cmp_eq_u32 s45, 0
  s_cbranch_scc1 L_sl_go
  s_cbranch_vccz L_sl_go
  s_branch L_sl_load
L_sl_go:
  s_nop 1
  v_add_f32_dpp v46, v46, v46 row_ror:4 row_mask:0xf bank_mask:0xf
  s_nop 1
  v_add_f32_dpp v46, v46, v46 row_ror:2 row_mask:0xf bank_mask:0xf
  s_nop 1
  v_add_f32_dpp v46, v46, v46 row_ror:1 row_mask:0xf bank_mask:0xf
  v_rcp_f32 v48, v46
  s_lshl_b32 s15, s44, 13
  s_lshl_b32 s19, s4, 10
  s_add_u32 s15, s15, s19
  s_lshl_b32 s19, s3, 8
  s_add_u32 s15, s15, s19
  v_pk_mul_f32 v[32:33], v[48:49], v[32:33] op_sel_hi:[0,1]
  v_lshlrev_b32 v26, 2, v1
  v_cvt_pk_bf16_f32 v32, v32, v33
  buffer_store_dword v32, v26, s[56:59], s15 offen
  s_cmp_eq_u32 s3, 0
  s_cbranch_scc0 L_sl_noep
  s_lshl_b32 s15, s4, 5
  s_lshl_b32 s19, s44, 2
  s_add_u32 s15, s15, s19
  v_mov_b32 v26, 0
  v_mov_b32 v27, s47
  s_mov_b64 exec, 1
  buffer_store_dword v27, v26, s[52:55], s15 offen
  s_mov_b64 exec, -1
L_sl_noep:
  s_branch L_fin_more
L_fin_exit:
L_end:
  s_endpgm
.section .rodata,"a"
.p2align 6
.amdhsa_kernel standalone__paged_block_table_kv_radixattention__decode_kernel
  .amdhsa_next_free_vgpr 396
  .amdhsa_next_free_sgpr 102
  .amdhsa_accum_offset 256
  .amdhsa_group_segment_fixed_size 0
  .amdhsa_kernarg_size 64
  .amdhsa_user_sgpr_count 2
  .amdhsa_user_sgpr_kernarg_segment_ptr 1
  .amdhsa_system_sgpr_workgroup_id_x 1
.end_amdhsa_kernel
```
